```python
import torch

def _softmax(x, axis=-1):
    return torch.softmax(x, dim=axis)
def _gelu(x):
    return torch.nn.functional.gelu(x, approximate="tanh")
def _silu(x):
    return torch.nn.functional.silu(x)
def _sigmoid(x):
    return torch.sigmoid(x)
def _layernorm(x, axis=-1, eps=1e-5):
    m = x.mean(dim=axis, keepdim=True)
    v = x.var(dim=axis, keepdim=True, unbiased=False)
    return (x - m) / torch.sqrt(v + eps)
def _scatter_add(tgt, idx, src, axis=0):
    return tgt.clone().index_add_(axis, idx, src)
def _segment_sum(src, seg, n):
    out = torch.zeros((n,) + src.shape[1:], dtype=src.dtype)
    return out.index_add_(0, seg, src)
def _pad(x, pw):
    flat = tuple(v for pair in reversed(pw) for v in pair)
    return torch.nn.functional.pad(x, flat)

kernel_name = 'interleave_layers__softmax_full_mha__mixer_token_mlp__prompt'

def setup_inputs():

    _w = (lambda a: (lambda t: t.to(torch.bfloat16) if t.is_floating_point() else t)(torch.as_tensor(a)))
    def _A_setup():
        B, S, D = 1, 2048, 512
        return {
            "x": _w((lambda *s: torch.randn(*s, dtype=torch.bfloat16) * 0.05)(B, S, D)),
            "wqkv": _w((lambda *s: torch.randn(*s, dtype=torch.bfloat16) * 0.05)(D, 3 * D)),
            "wo": _w((lambda *s: torch.randn(*s, dtype=torch.bfloat16) * 0.05)(D, D)),
        }
    _A_in = _A_setup()

    def _B_setup():
        B, S, D, F = 1, 2048, 512, 1792
        return {
            "x": _w((lambda *s: torch.randn(*s, dtype=torch.bfloat16) * 0.05)(B, S, D)),
            "w1": _w((lambda *s: torch.randn(*s, dtype=torch.bfloat16) * 0.8)(S, F) * (S ** -0.5)),
            "b1": _w((lambda *s: torch.randn(*s, dtype=torch.bfloat16) * 12.8)(F) * 0.02),
            "w2": _w((lambda *s: torch.randn(*s, dtype=torch.bfloat16) * 0.2)(F, S) * (F ** -0.5)),
            "b2": _w((lambda *s: torch.randn(*s, dtype=torch.bfloat16) * 3.2)(S) * 0.02),
        }
    _B_in = _B_setup()

    return {
        "A_x": _A_in["x"],
        "A_wqkv": _A_in["wqkv"],
        "A_wo": _A_in["wo"],
        "B_x": _B_in["x"],
        "B_w1": _B_in["w1"],
        "B_b1": _B_in["b1"],
        "B_w2": _B_in["w2"],
        "B_b2": _B_in["b2"],
    }

def reference(A_x, A_wqkv, A_wo, B_x, B_w1, B_b1, B_w2, B_b2):
    def _A_ref(x, wqkv, wo):
        B, S, D = x.shape
        H = 32; Dh = D // H
        qkv = (lambda x, *d: x.permute(*d))((x @ wqkv).reshape(B, S, 3, H, Dh), 2, 0, 3, 1, 4)
        q, k, v = qkv[0], qkv[1], qkv[2]
        scale = Dh ** -0.5
        scores = torch.einsum("bhqd,bhkd->bhqk", q, k) * scale
        p = _softmax(scores, axis=-1)
        o = torch.einsum("bhqk,bhkd->bhqd", p, v)
        return (lambda x, *d: x.permute(*d))(o, 0, 2, 1, 3).reshape(B, S, D) @ wo

    def _B_ref(x, w1, b1, w2, b2):
        B, S, D = x.shape
        h = _layernorm(x, axis=-1)
        u = torch.einsum("bsd,sf->bdf", h, w1) + b1
        u = _gelu(u)
        y = torch.einsum("bdf,fs->bds", u, w2) + b2
        return (lambda x, *d: x.permute(*d))(y, 0, 2, 1)

    x = A_x
    x = x + _A_ref(_layernorm(x, axis=-1), A_wqkv, A_wo)
    x = x + _B_ref(_layernorm(x, axis=-1), B_w1, B_b1, B_w2, B_b2)
    x = x + _A_ref(_layernorm(x, axis=-1), A_wqkv, A_wo)
    x = x + _B_ref(_layernorm(x, axis=-1), B_w1, B_b1, B_w2, B_b2)
    return x
```

```asm
; @launch grid=(256,1,1) block=(512,1,1) lds=163840
.amdgcn_target "amdgcn-amd-amdhsa--gfx950"
.text
.globl interleave_layers__softmax_full_mha__mixer_token_mlp__prompt_kernel
.p2align 8
.type interleave_layers__softmax_full_mha__mixer_token_mlp__prompt_kernel,@function
interleave_layers__softmax_full_mha__mixer_token_mlp__prompt_kernel:
    s_load_dwordx16 s[64:79], s[0:1], 0
    s_load_dwordx4 s[84:87], s[0:1], 64
    s_load_dwordx2 s[88:89], s[0:1], 80
    s_cmp_ge_u32 s2, 256
    s_cbranch_scc1 L_end
    v_lshrrev_b32 v1, 6, v0
    s_lshr_b32 s49, s2, 5
    v_readfirstlane_b32 s50, v1
    v_and_b32 v1, 63, v0
    s_and_b32 s48, s2, 7
    s_lshl_b32 s48, s48, 2
    s_bfe_u32 s60, s2, 0x20003
    s_or_b32 s48, s48, s60
    v_lshrrev_b32 v2, 3, v0
    v_and_b32 v3, 7, v0
    s_lshl_b32 s60, s49, 3
    v_add_u32 v42, s60, v2
    v_and_b32 v42, 63, v42
    v_bfe_u32 v41, v42, 1, 3
    v_xor_b32 v41, v41, v3
    v_lshlrev_b32 v41, 4, v41
    v_lshl_add_u32 v15, v42, 10, v41
    s_mov_b32 s10, 0x200000
    s_mov_b32 s11, 0x00020000
    s_mov_b32 s14, 0x180000
    s_mov_b32 s15, s11
    s_and_b32 s80, s48, 0
    s_lshl_b32 s80, s80, 1
    s_mul_i32 s62, s2, 6144
    s_lshr_b32 s63, s2, 3
    s_mul_i32 s63, s63, 49152
    s_addk_i32 s63, 384
    s_cmp_eq_u32 s50, 0
    s_cselect_b32 s62, s62, s63
    s_cselect_b32 s63, 7, 10
    v_min_u32 v41, 47, v1
    v_lshlrev_b32 v41, s63, v41
    s_cmp_gt_u32 s50, 1
    s_waitcnt lgkmcnt(0)
    s_mov_b64 s[8:9], s[64:65]
    s_mov_b64 s[12:13], s[66:67]
    s_cbranch_scc1 L1
    buffer_load_dword v143, v41, s[12:15], s62 offen
L1:
    s_lshl_b32 s60, s48, 16
    s_add_u32 s61, s50, s49
    s_and_b32 s61, s61, 7
    s_lshl_b32 s61, s61, 10
    s_add_u32 m0, s61, 0
    s_nop 0
    buffer_load_dwordx4 v15, s[8:11], s60 offen offset:0  lds
    s_add_u32 m0, s61, 8064
    s_nop 0
    buffer_load_dwordx4 v15, s[8:11], s60 offen offset:128  lds
    s_add_u32 m0, s61, 16128
    s_nop 0
    buffer_load_dwordx4 v15, s[8:11], s60 offen offset:256  lds
    s_add_u32 m0, s61, 24192
    s_nop 0
    buffer_load_dwordx4 v15, s[8:11], s60 offen offset:384  lds
    s_add_u32 m0, s61, 32256
    s_nop 0
    buffer_load_dwordx4 v15, s[8:11], s60 offen offset:512  lds
    s_add_u32 m0, s61, 40320
    s_nop 0
    buffer_load_dwordx4 v15, s[8:11], s60 offen offset:640  lds
    s_add_u32 m0, s61, 48384
    s_nop 0
    buffer_load_dwordx4 v15, s[8:11], s60 offen offset:768  lds
    s_add_u32 m0, s61, 56448
    s_nop 0
    buffer_load_dwordx4 v15, s[8:11], s60 offen offset:896  lds
    s_mov_b64 s[20:21], s[68:69]
    s_mov_b64 s[24:25], s[72:73]
    s_mov_b64 s[28:29], s[76:77]
    s_mov_b64 s[32:33], s[74:75]
    s_mov_b64 s[36:37], s[78:79]
    s_mov_b64 s[58:59], s[84:85]
    s_mov_b64 s[44:45], s[86:87]
    s_mov_b64 s[16:17], s[88:89]
    s_add_u32 s40, s16, 4194304
    s_addc_u32 s41, s17, 0
    s_mov_b32 s18, 0x10000000
    s_mov_b32 s19, 0x00020000
    s_mov_b32 s22, 0x80000
    s_mov_b32 s23, 0x00020000
    s_mov_b32 s26, 0x700000
    s_mov_b32 s27, 0x00020000
    s_mov_b32 s30, 0x700000
    s_mov_b32 s31, 0x00020000
    s_mov_b32 s34, 0xe00
    s_mov_b32 s35, 0x00020000
    s_mov_b32 s38, 0x1000
    s_mov_b32 s39, 0x00020000
    s_mov_b32 s46, 0x100
    s_mov_b32 s47, 0x00020000
    s_mov_b32 s42, 0x200000
    s_mov_b32 s43, 0x00020000
    v_lshlrev_b32 v4, 4, v1
    s_lshl_b32 s57, s48, 16
    s_lshl_b32 s60, s49, 7
    s_add_u32 s57, s57, s60
    s_mov_b32 s56, 0
    s_mov_b32 s51, 0
    s_mov_b32 s52, 0
    s_mov_b32 s53, 33554432
    v_lshrrev_b32 v40, 3, v1
    v_bfe_u32 v43, v1, 4, 1
    v_lshlrev_b32 v43, 2, v43
    v_and_b32 v42, 7, v1
    v_xor_b32 v43, v43, v42
    v_lshlrev_b32 v43, 4, v43
    v_mul_u32_u24 v14, 3072, v40
    v_add_u32 v14, v14, v43
    s_lshl_b32 s55, s50, 10
    s_add_u32 s55, s55, 65536
    v_bfe_u32 v43, v2, 1, 1
    v_bfe_u32 v42, v2, 2, 1
    v_and_b32 v2, 0x39, v2
    v_lshl_add_u32 v2, v43, 2, v2
    v_lshl_add_u32 v2, v42, 1, v2
    v_lshlrev_b32 v5, 10, v2
    v_lshl_add_u32 v5, v3, 4, v5
    s_and_b32 s83, s49, 6
    s_lshr_b32 s60, s48, 2
    s_add_u32 s83, s83, s60
    s_and_b32 s83, s83, 7
    v_lshrrev_b32 v42, 2, v1
    v_and_b32 v43, 3, v1
    v_lshlrev_b32 v43, 4, v43
    v_lshl_add_u32 v12, v42, 12, v43
    v_lshrrev_b32 v42, 5, v1
    v_lshlrev_b32 v42, 3, v42
    v_bfe_u32 v43, v1, 2, 2
    v_add_u32 v42, v42, v43
    v_lshlrev_b32 v13, 6, v42
    v_bfe_u32 v43, v1, 4, 1
    v_lshl_add_u32 v13, v43, 5, v13
    v_and_b32 v43, 3, v1
    v_lshl_add_u32 v13, v43, 3, v13
    v_add_u32 v13, s55, v13
    v_add_u32 v13, 32768, v13
    s_lshr_b32 s54, s50, 1
    s_mul_i32 s54, s54, 1835008
    s_lshl_b32 s60, s48, 7
    s_add_u32 s54, s54, s60
    s_and_b32 s60, s50, 1
    s_lshl_b32 s60, s60, 6
    s_add_u32 s54, s54, s60
    buffer_load_dwordx4 v[8:11], v5, s[8:11], s57 offen
    s_cmp_lt_u32 s50, 4
    s_cbranch_scc1 L_p1_cons
    s_cmp_ge_u32 s50, 6
    s_cbranch_scc1 L2
    s_sub_u32 s63, s50, 4
    s_mul_i32 s62, s63, 98304
    s_lshl_b32 s60, s49, 7
    s_add_u32 s62, s62, s60
    s_lshl_b32 s63, s63, 12
    s_add_u32 s63, s63, 65536
    s_mov_b32 s61, s62
    s_add_u32 m0, s63, 40960
    s_add_u32 s60, s61, 1024
    buffer_load_dwordx4 v14, s[12:15], s60 offen lds
    s_add_u32 m0, s63, 41984
    s_add_u32 s60, s61, 25600
    buffer_load_dwordx4 v14, s[12:15], s60 offen lds
    s_add_u32 m0, s63, 43008
    s_add_u32 s60, s61, 50176
    buffer_load_dwordx4 v14, s[12:15], s60 offen lds
    s_add_u32 m0, s63, 44032
    s_add_u32 s60, s61, 74752
    buffer_load_dwordx4 v14, s[12:15], s60 offen lds
    s_mov_b32 s61, s62
    s_add_u32 m0, s63, 49152
    s_add_u32 s60, s61, 2048
    buffer_load_dwordx4 v14, s[12:15], s60 offen lds
    s_add_u32 m0, s63, 50176
    s_add_u32 s60, s61, 26624
    buffer_load_dwordx4 v14, s[12:15], s60 offen lds
    s_add_u32 m0, s63, 51200
    s_add_u32 s60, s61, 51200
    buffer_load_dwordx4 v14, s[12:15], s60 offen lds
    s_add_u32 m0, s63, 52224
    s_add_u32 s60, s61, 75776
    buffer_load_dwordx4 v14, s[12:15], s60 offen lds
    s_mov_b32 s61, s62
    s_add_u32 m0, s63, 57344
    s_add_u32 s60, s61, 197632
    buffer_load_dwordx4 v14, s[12:15], s60 offen lds
    s_add_u32 m0, s63, 58368
    s_add_u32 s60, s61, 222208
    buffer_load_dwordx4 v14, s[12:15], s60 offen lds
    s_add_u32 m0, s63, 59392
    s_add_u32 s60, s61, 246784
    buffer_load_dwordx4 v14, s[12:15], s60 offen lds
    s_add_u32 m0, s63, 60416
    s_add_u32 s60, s61, 271360
    buffer_load_dwordx4 v14, s[12:15], s60 offen lds
    s_mov_b32 s61, s62
    s_add_u32 m0, s63, 65536
    s_add_u32 s60, s61, 198656
    buffer_load_dwordx4 v14, s[12:15], s60 offen lds
    s_add_u32 m0, s63, 66560
    s_add_u32 s60, s61, 223232
    buffer_load_dwordx4 v14, s[12:15], s60 offen lds
    s_add_u32 m0, s63, 67584
    s_add_u32 s60, s61, 247808
    buffer_load_dwordx4 v14, s[12:15], s60 offen lds
    s_add_u32 m0, s63, 68608
    s_add_u32 s60, s61, 272384
    buffer_load_dwordx4 v14, s[12:15], s60 offen lds
    s_waitcnt vmcnt(16)
    s_add_u32 s60, s50, s49
    s_and_b32 s60, s60, 7
    s_lshl_b32 s61, s60, 10
    v_add_u32 v40, s61, v4
    ds_read_b128 v[48:51], v40 offset:0
    ds_read_b128 v[52:55], v40 offset:8192
    ds_read_b128 v[56:59], v40 offset:16384
    ds_read_b128 v[60:63], v40 offset:24576
    ds_read_b128 v[64:67], v40 offset:32768
    ds_read_b128 v[68:71], v40 offset:40960
    ds_read_b128 v[72:75], v40 offset:49152
    ds_read_b128 v[76:79], v40 offset:57344
    v_mov_b32 v80, 0
    v_mov_b32 v81, 0
    v_mov_b32 v82, 0
    v_mov_b32 v83, 0
    v_mov_b32 v84, 0x3f803f80
    s_lshl_b32 s60, s60, 5
    s_add_u32 s60, s60, 106496
    v_lshrrev_b32 v40, 3, v1
    v_lshlrev_b32 v40, 2, v40
    v_add_u32 v40, s60, v40
    s_waitcnt lgkmcnt(7)
    v_dot2c_f32_bf16 v80, v48, v84
    v_dot2c_f32_bf16 v82, v48, v48
    v_dot2c_f32_bf16 v81, v49, v84
    v_dot2c_f32_bf16 v83, v49, v49
    v_dot2c_f32_bf16 v80, v50, v84
    v_dot2c_f32_bf16 v82, v50, v50
    v_dot2c_f32_bf16 v81, v51, v84
    v_dot2c_f32_bf16 v83, v51, v51
    s_waitcnt lgkmcnt(6)
    v_dot2c_f32_bf16 v80, v52, v84
    v_dot2c_f32_bf16 v82, v52, v52
    v_dot2c_f32_bf16 v81, v53, v84
    v_dot2c_f32_bf16 v83, v53, v53
    v_dot2c_f32_bf16 v80, v54, v84
    v_dot2c_f32_bf16 v82, v54, v54
    v_dot2c_f32_bf16 v81, v55, v84
    v_dot2c_f32_bf16 v83, v55, v55
    s_waitcnt lgkmcnt(5)
    v_dot2c_f32_bf16 v80, v56, v84
    v_dot2c_f32_bf16 v82, v56, v56
    v_dot2c_f32_bf16 v81, v57, v84
    v_dot2c_f32_bf16 v83, v57, v57
    v_dot2c_f32_bf16 v80, v58, v84
    v_dot2c_f32_bf16 v82, v58, v58
    v_dot2c_f32_bf16 v81, v59, v84
    v_dot2c_f32_bf16 v83, v59, v59
    s_waitcnt lgkmcnt(4)
    v_dot2c_f32_bf16 v80, v60, v84
    v_dot2c_f32_bf16 v82, v60, v60
    v_dot2c_f32_bf16 v81, v61, v84
    v_dot2c_f32_bf16 v83, v61, v61
    v_dot2c_f32_bf16 v80, v62, v84
    v_dot2c_f32_bf16 v82, v62, v62
    v_dot2c_f32_bf16 v81, v63, v84
    v_dot2c_f32_bf16 v83, v63, v63
    s_waitcnt lgkmcnt(3)
    v_dot2c_f32_bf16 v80, v64, v84
    v_dot2c_f32_bf16 v82, v64, v64
    v_dot2c_f32_bf16 v81, v65, v84
    v_dot2c_f32_bf16 v83, v65, v65
    v_dot2c_f32_bf16 v80, v66, v84
    v_dot2c_f32_bf16 v82, v66, v66
    v_dot2c_f32_bf16 v81, v67, v84
    v_dot2c_f32_bf16 v83, v67, v67
    s_waitcnt lgkmcnt(2)
    v_dot2c_f32_bf16 v80, v68, v84
    v_dot2c_f32_bf16 v82, v68, v68
    v_dot2c_f32_bf16 v81, v69, v84
    v_dot2c_f32_bf16 v83, v69, v69
    v_dot2c_f32_bf16 v80, v70, v84
    v_dot2c_f32_bf16 v82, v70, v70
    v_dot2c_f32_bf16 v81, v71, v84
    v_dot2c_f32_bf16 v83, v71, v71
    s_waitcnt lgkmcnt(1)
    v_dot2c_f32_bf16 v80, v72, v84
    v_dot2c_f32_bf16 v82, v72, v72
    v_dot2c_f32_bf16 v81, v73, v84
    v_dot2c_f32_bf16 v83, v73, v73
    v_dot2c_f32_bf16 v80, v74, v84
    v_dot2c_f32_bf16 v82, v74, v74
    v_dot2c_f32_bf16 v81, v75, v84
    v_dot2c_f32_bf16 v83, v75, v75
    s_waitcnt lgkmcnt(0)
    v_dot2c_f32_bf16 v80, v76, v84
    v_dot2c_f32_bf16 v82, v76, v76
    v_dot2c_f32_bf16 v81, v77, v84
    v_dot2c_f32_bf16 v83, v77, v77
    v_dot2c_f32_bf16 v80, v78, v84
    v_dot2c_f32_bf16 v82, v78, v78
    v_dot2c_f32_bf16 v81, v79, v84
    v_dot2c_f32_bf16 v83, v79, v79
    s_nop 2
    v_add_f32 v42, v80, v81
    v_add_f32 v44, v82, v83
    s_nop 1
    v_add_f32_dpp v42, v42, v42 quad_perm:[1,0,3,2] row_mask:0xf bank_mask:0xf
    v_add_f32_dpp v44, v44, v44 quad_perm:[1,0,3,2] row_mask:0xf bank_mask:0xf
    s_nop 1
    v_add_f32_dpp v42, v42, v42 quad_perm:[2,3,0,1] row_mask:0xf bank_mask:0xf
    v_add_f32_dpp v44, v44, v44 quad_perm:[2,3,0,1] row_mask:0xf bank_mask:0xf
    s_nop 1
    v_add_f32_dpp v42, v42, v42 row_half_mirror row_mask:0xf bank_mask:0xf
    v_add_f32_dpp v44, v44, v44 row_half_mirror row_mask:0xf bank_mask:0xf
    v_mul_f32 v42, 0x3b000000, v42
    v_mul_f32 v44, 0x3b000000, v44
    v_fma_f32 v44, -v42, v42, v44
    v_max_f32 v44, 0, v44
    v_add_f32 v44, 0x3727c5ac, v44
    v_rsq_f32 v44, v44
    s_mov_b32 s61, s62
    s_add_u32 m0, s63, 73728
    s_add_u32 s60, s61, 394240
    buffer_load_dwordx4 v14, s[12:15], s60 offen lds
    s_add_u32 m0, s63, 74752
    s_add_u32 s60, s61, 418816
    buffer_load_dwordx4 v14, s[12:15], s60 offen lds
    s_add_u32 m0, s63, 75776
    s_add_u32 s60, s61, 443392
    buffer_load_dwordx4 v14, s[12:15], s60 offen lds
    s_add_u32 m0, s63, 76800
    s_add_u32 s60, s61, 467968
    buffer_load_dwordx4 v14, s[12:15], s60 offen lds
    s_mov_b32 s61, s62
    s_add_u32 m0, s63, 81920
    s_add_u32 s60, s61, 395264
    buffer_load_dwordx4 v14, s[12:15], s60 offen lds
    s_add_u32 m0, s63, 82944
    s_add_u32 s60, s61, 419840
    buffer_load_dwordx4 v14, s[12:15], s60 offen lds
    s_add_u32 m0, s63, 83968
    s_add_u32 s60, s61, 444416
    buffer_load_dwordx4 v14, s[12:15], s60 offen lds
    s_add_u32 m0, s63, 84992
    s_add_u32 s60, s61, 468992
    buffer_load_dwordx4 v14, s[12:15], s60 offen lds
    s_mov_b32 s61, s62
    s_add_u32 m0, s63, 90112
    s_add_u32 s60, s61, 590848
    buffer_load_dwordx4 v14, s[12:15], s60 offen lds
    s_add_u32 m0, s63, 91136
    s_add_u32 s60, s61, 615424
    buffer_load_dwordx4 v14, s[12:15], s60 offen lds
    s_add_u32 m0, s63, 92160
    s_add_u32 s60, s61, 640000
    buffer_load_dwordx4 v14, s[12:15], s60 offen lds
    s_add_u32 m0, s63, 93184
    s_add_u32 s60, s61, 664576
    buffer_load_dwordx4 v14, s[12:15], s60 offen lds
    s_mov_b32 s61, s62
    s_add_u32 m0, s63, 0
    s_add_u32 s60, s61, 591872
    buffer_load_dwordx4 v14, s[12:15], s60 offen lds
    s_add_u32 m0, s63, 1024
    s_add_u32 s60, s61, 616448
    buffer_load_dwordx4 v14, s[12:15], s60 offen lds
    s_add_u32 m0, s63, 2048
    s_add_u32 s60, s61, 641024
    buffer_load_dwordx4 v14, s[12:15], s60 offen lds
    s_add_u32 m0, s63, 3072
    s_add_u32 s60, s61, 665600
    buffer_load_dwordx4 v14, s[12:15], s60 offen lds
    s_waitcnt vmcnt(24)
    s_barrier
    s_mov_b32 s61, s62
    s_add_u32 m0, s63, 8192
    s_add_u32 s60, s61, 787456
    buffer_load_dwordx4 v14, s[12:15], s60 offen lds
    s_add_u32 m0, s63, 9216
    s_add_u32 s60, s61, 812032
    buffer_load_dwordx4 v14, s[12:15], s60 offen lds
    s_add_u32 m0, s63, 10240
    s_add_u32 s60, s61, 836608
    buffer_load_dwordx4 v14, s[12:15], s60 offen lds
    s_add_u32 m0, s63, 11264
    s_add_u32 s60, s61, 861184
    buffer_load_dwordx4 v14, s[12:15], s60 offen lds
    s_mov_b32 s61, s62
    s_add_u32 m0, s63, 16384
    s_add_u32 s60, s61, 788480
    buffer_load_dwordx4 v14, s[12:15], s60 offen lds
    s_add_u32 m0, s63, 17408
    s_add_u32 s60, s61, 813056
    buffer_load_dwordx4 v14, s[12:15], s60 offen lds
    s_add_u32 m0, s63, 18432
    s_add_u32 s60, s61, 837632
    buffer_load_dwordx4 v14, s[12:15], s60 offen lds
    s_add_u32 m0, s63, 19456
    s_add_u32 s60, s61, 862208
    buffer_load_dwordx4 v14, s[12:15], s60 offen lds
    s_waitcnt vmcnt(24)
    s_barrier
    s_mov_b32 s61, s62
    s_add_u32 m0, s63, 24576
    s_add_u32 s60, s61, 984064
    buffer_load_dwordx4 v14, s[12:15], s60 offen lds
    s_add_u32 m0, s63, 25600
    s_add_u32 s60, s61, 1008640
    buffer_load_dwordx4 v14, s[12:15], s60 offen lds
    s_add_u32 m0, s63, 26624
    s_add_u32 s60, s61, 1033216
    buffer_load_dwordx4 v14, s[12:15], s60 offen lds
    s_add_u32 m0, s63, 27648
    s_add_u32 s60, s61, 1057792
    buffer_load_dwordx4 v14, s[12:15], s60 offen lds
    s_mov_b32 s61, s62
    s_add_u32 m0, s63, 32768
    s_add_u32 s60, s61, 985088
    buffer_load_dwordx4 v14, s[12:15], s60 offen lds
    s_add_u32 m0, s63, 33792
    s_add_u32 s60, s61, 1009664
    buffer_load_dwordx4 v14, s[12:15], s60 offen lds
    s_add_u32 m0, s63, 34816
    s_add_u32 s60, s61, 1034240
    buffer_load_dwordx4 v14, s[12:15], s60 offen lds
    s_add_u32 m0, s63, 35840
    s_add_u32 s60, s61, 1058816
    buffer_load_dwordx4 v14, s[12:15], s60 offen lds
    s_waitcnt vmcnt(24)
    s_barrier
    s_mov_b32 s61, s62
    s_add_u32 m0, s63, 40960
    s_add_u32 s60, s61, 1180672
    buffer_load_dwordx4 v14, s[12:15], s60 offen lds
    s_add_u32 m0, s63, 41984
    s_add_u32 s60, s61, 1205248
    buffer_load_dwordx4 v14, s[12:15], s60 offen lds
    s_add_u32 m0, s63, 43008
    s_add_u32 s60, s61, 1229824
    buffer_load_dwordx4 v14, s[12:15], s60 offen lds
    s_add_u32 m0, s63, 44032
    s_add_u32 s60, s61, 1254400
    buffer_load_dwordx4 v14, s[12:15], s60 offen lds
    s_mov_b32 s61, s62
    s_add_u32 m0, s63, 49152
    s_add_u32 s60, s61, 1181696
    buffer_load_dwordx4 v14, s[12:15], s60 offen lds
    s_add_u32 m0, s63, 50176
    s_add_u32 s60, s61, 1206272
    buffer_load_dwordx4 v14, s[12:15], s60 offen lds
    s_add_u32 m0, s63, 51200
    s_add_u32 s60, s61, 1230848
    buffer_load_dwordx4 v14, s[12:15], s60 offen lds
    s_add_u32 m0, s63, 52224
    s_add_u32 s60, s61, 1255424
    buffer_load_dwordx4 v14, s[12:15], s60 offen lds
    s_waitcnt vmcnt(24)
    s_barrier
    s_mov_b32 s61, s62
    s_add_u32 m0, s63, 57344
    s_add_u32 s60, s61, 1377280
    buffer_load_dwordx4 v14, s[12:15], s60 offen lds
    s_add_u32 m0, s63, 58368
    s_add_u32 s60, s61, 1401856
    buffer_load_dwordx4 v14, s[12:15], s60 offen lds
    s_add_u32 m0, s63, 59392
    s_add_u32 s60, s61, 1426432
    buffer_load_dwordx4 v14, s[12:15], s60 offen lds
    s_add_u32 m0, s63, 60416
    s_add_u32 s60, s61, 1451008
    buffer_load_dwordx4 v14, s[12:15], s60 offen lds
    s_mov_b32 s61, s62
    s_add_u32 m0, s63, 65536
    s_add_u32 s60, s61, 1378304
    buffer_load_dwordx4 v14, s[12:15], s60 offen lds
    s_add_u32 m0, s63, 66560
    s_add_u32 s60, s61, 1402880
    buffer_load_dwordx4 v14, s[12:15], s60 offen lds
    s_add_u32 m0, s63, 67584
    s_add_u32 s60, s61, 1427456
    buffer_load_dwordx4 v14, s[12:15], s60 offen lds
    s_add_u32 m0, s63, 68608
    s_add_u32 s60, s61, 1452032
    buffer_load_dwordx4 v14, s[12:15], s60 offen lds
    s_waitcnt vmcnt(24)
    s_barrier
    s_mov_b32 s61, s62
    s_add_u32 m0, s63, 73728
    s_add_u32 s60, s61, 0
    buffer_load_dwordx4 v14, s[12:15], s60 offen lds
    s_add_u32 m0, s63, 74752
    s_add_u32 s60, s61, 24576
    buffer_load_dwordx4 v14, s[12:15], s60 offen lds
    s_add_u32 m0, s63, 75776
    s_add_u32 s60, s61, 49152
    buffer_load_dwordx4 v14, s[12:15], s60 offen lds
    s_add_u32 m0, s63, 76800
    s_add_u32 s60, s61, 73728
    buffer_load_dwordx4 v14, s[12:15], s60 offen lds
    s_mov_b32 s61, s62
    s_add_u32 m0, s63, 81920
    s_add_u32 s60, s61, 196608
    buffer_load_dwordx4 v14, s[12:15], s60 offen lds
    s_add_u32 m0, s63, 82944
    s_add_u32 s60, s61, 221184
    buffer_load_dwordx4 v14, s[12:15], s60 offen lds
    s_add_u32 m0, s63, 83968
    s_add_u32 s60, s61, 245760
    buffer_load_dwordx4 v14, s[12:15], s60 offen lds
    s_add_u32 m0, s63, 84992
    s_add_u32 s60, s61, 270336
    buffer_load_dwordx4 v14, s[12:15], s60 offen lds
    s_waitcnt vmcnt(24)
    s_barrier
    s_mov_b32 s61, s62
    s_add_u32 m0, s63, 90112
    s_add_u32 s60, s61, 393216
    buffer_load_dwordx4 v14, s[12:15], s60 offen lds
    s_add_u32 m0, s63, 91136
    s_add_u32 s60, s61, 417792
    buffer_load_dwordx4 v14, s[12:15], s60 offen lds
    s_add_u32 m0, s63, 92160
    s_add_u32 s60, s61, 442368
    buffer_load_dwordx4 v14, s[12:15], s60 offen lds
    s_add_u32 m0, s63, 93184
    s_add_u32 s60, s61, 466944
    buffer_load_dwordx4 v14, s[12:15], s60 offen lds
    s_mov_b32 s61, s62
    s_add_u32 m0, s63, 0
    s_add_u32 s60, s61, 589824
    buffer_load_dwordx4 v14, s[12:15], s60 offen lds
    s_add_u32 m0, s63, 1024
    s_add_u32 s60, s61, 614400
    buffer_load_dwordx4 v14, s[12:15], s60 offen lds
    s_add_u32 m0, s63, 2048
    s_add_u32 s60, s61, 638976
    buffer_load_dwordx4 v14, s[12:15], s60 offen lds
    s_add_u32 m0, s63, 3072
    s_add_u32 s60, s61, 663552
    buffer_load_dwordx4 v14, s[12:15], s60 offen lds
    s_waitcnt vmcnt(24)
    s_barrier
    s_mov_b32 s61, s62
    s_add_u32 m0, s63, 8192
    s_add_u32 s60, s61, 786432
    buffer_load_dwordx4 v14, s[12:15], s60 offen lds
    s_add_u32 m0, s63, 9216
    s_add_u32 s60, s61, 811008
    buffer_load_dwordx4 v14, s[12:15], s60 offen lds
    s_add_u32 m0, s63, 10240
    s_add_u32 s60, s61, 835584
    buffer_load_dwordx4 v14, s[12:15], s60 offen lds
    s_add_u32 m0, s63, 11264
    s_add_u32 s60, s61, 860160
    buffer_load_dwordx4 v14, s[12:15], s60 offen lds
    s_mov_b32 s61, s62
    s_add_u32 m0, s63, 16384
    s_add_u32 s60, s61, 983040
    buffer_load_dwordx4 v14, s[12:15], s60 offen lds
    s_add_u32 m0, s63, 17408
    s_add_u32 s60, s61, 1007616
    buffer_load_dwordx4 v14, s[12:15], s60 offen lds
    s_add_u32 m0, s63, 18432
    s_add_u32 s60, s61, 1032192
    buffer_load_dwordx4 v14, s[12:15], s60 offen lds
    s_add_u32 m0, s63, 19456
    s_add_u32 s60, s61, 1056768
    buffer_load_dwordx4 v14, s[12:15], s60 offen lds
    s_waitcnt vmcnt(24)
    s_barrier
    ds_write_b32 v40, v42
    ds_write_b32 v40, v44 offset:256
    s_mov_b32 s61, s62
    s_add_u32 m0, s63, 24576
    s_add_u32 s60, s61, 1179648
    buffer_load_dwordx4 v14, s[12:15], s60 offen lds
    s_add_u32 m0, s63, 25600
    s_add_u32 s60, s61, 1204224
    buffer_load_dwordx4 v14, s[12:15], s60 offen lds
    s_add_u32 m0, s63, 26624
    s_add_u32 s60, s61, 1228800
    buffer_load_dwordx4 v14, s[12:15], s60 offen lds
    s_add_u32 m0, s63, 27648
    s_add_u32 s60, s61, 1253376
    buffer_load_dwordx4 v14, s[12:15], s60 offen lds
    s_mov_b32 s61, s62
    s_add_u32 m0, s63, 32768
    s_add_u32 s60, s61, 1376256
    buffer_load_dwordx4 v14, s[12:15], s60 offen lds
    s_add_u32 m0, s63, 33792
    s_add_u32 s60, s61, 1400832
    buffer_load_dwordx4 v14, s[12:15], s60 offen lds
    s_add_u32 m0, s63, 34816
    s_add_u32 s60, s61, 1425408
    buffer_load_dwordx4 v14, s[12:15], s60 offen lds
    s_add_u32 m0, s63, 35840
    s_add_u32 s60, s61, 1449984
    buffer_load_dwordx4 v14, s[12:15], s60 offen lds
    s_waitcnt vmcnt(24) lgkmcnt(0)
    s_barrier
    s_waitcnt vmcnt(16)
    s_barrier
    s_waitcnt vmcnt(8)
    s_barrier
    s_waitcnt vmcnt(0)
    s_barrier
    s_barrier
    s_branch L_p1_join
L2:
    s_cmp_lg_u32 s50, 7
    s_cbranch_scc1 L3
    v_mov_b32 v44, 0
    v_mov_b32 v45, 0
    v_mov_b32 v46, 0
    v_mov_b32 v47, 0
    s_lshl_b32 s60, s2, 10
    s_add_u32 s60, s60, 12582912
    s_add_u32 s61, s60, 16777216
    buffer_store_dwordx4 v[44:47], v4, s[16:19], s60 offen sc1
    buffer_store_dwordx4 v[44:47], v4, s[16:19], s61 offen sc1
    s_add_u32 s61, s60, 262144
    buffer_store_dwordx4 v[44:47], v4, s[16:19], s61 offen sc1
    s_lshl_b32 s60, s2, 9
    s_add_u32 s60, s60, 33554432
    s_mov_b32 exec_hi, 0
    buffer_store_dwordx4 v[44:47], v4, s[16:19], s60 offen sc1
    s_mov_b64 exec, -1
    v_mov_b32 v100, -1
    v_mov_b32 v101, -1
    v_mov_b32 v102, -1
    v_mov_b32 v103, -1
    s_lshl_b32 s60, s2, 13
    s_add_u32 s60, s60, 4194304
    s_add_u32 s61, s60, 4096
    buffer_store_dwordx4 v[100:103], v4, s[16:19], s60 offen offset:0 sc1
    buffer_store_dwordx4 v[100:103], v4, s[16:19], s60 offen offset:1024 sc1
    buffer_store_dwordx4 v[100:103], v4, s[16:19], s60 offen offset:2048 sc1
    buffer_store_dwordx4 v[100:103], v4, s[16:19], s60 offen offset:3072 sc1
    buffer_store_dwordx4 v[100:103], v4, s[16:19], s61 offen offset:0 sc1
    buffer_store_dwordx4 v[100:103], v4, s[16:19], s61 offen offset:1024 sc1
    buffer_store_dwordx4 v[100:103], v4, s[16:19], s61 offen offset:2048 sc1
    buffer_store_dwordx4 v[100:103], v4, s[16:19], s61 offen offset:3072 sc1
    s_getreg_b32 s61, hwreg(HW_REG_XCC_ID, 0, 4)
    s_mov_b64 exec, 1
    v_mov_b32 v48, s61
    s_lshl_b32 s60, s48, 3
    s_add_u32 s60, s60, s49
    s_lshl_b32 s60, s60, 4
    s_add_u32 s60, s60, 33685504
    buffer_store_dword v48, v4, s[16:19], s60 offen sc1
    s_mov_b64 exec, -1
L3:
    s_waitcnt vmcnt(13)
    s_cmp_eq_u32 s50, 7
    s_cbranch_scc1 L4
    s_waitcnt vmcnt(0)
L4:
    s_add_u32 s60, s50, s49
    s_and_b32 s60, s60, 7
    s_lshl_b32 s61, s60, 10
    v_add_u32 v40, s61, v4
    ds_read_b128 v[52:55], v40 offset:0
    ds_read_b128 v[56:59], v40 offset:8192
    ds_read_b128 v[60:63], v40 offset:16384
    ds_read_b128 v[64:67], v40 offset:24576
    ds_read_b128 v[68:71], v40 offset:32768
    ds_read_b128 v[72:75], v40 offset:40960
    ds_read_b128 v[76:79], v40 offset:49152
    ds_read_b128 v[80:83], v40 offset:57344
    v_mov_b32 v84, 0
    v_mov_b32 v85, 0
    v_mov_b32 v86, 0
    v_mov_b32 v87, 0
    v_mov_b32 v88, 0x3f803f80
    s_lshl_b32 s60, s60, 5
    s_add_u32 s60, s60, 106496
    v_lshrrev_b32 v40, 3, v1
    v_lshlrev_b32 v40, 2, v40
    v_add_u32 v40, s60, v40
    s_waitcnt lgkmcnt(7)
    v_dot2c_f32_bf16 v84, v52, v88
    v_dot2c_f32_bf16 v86, v52, v52
    v_dot2c_f32_bf16 v85, v53, v88
    v_dot2c_f32_bf16 v87, v53, v53
    v_dot2c_f32_bf16 v84, v54, v88
    v_dot2c_f32_bf16 v86, v54, v54
    v_dot2c_f32_bf16 v85, v55, v88
    v_dot2c_f32_bf16 v87, v55, v55
    s_waitcnt lgkmcnt(6)
    v_dot2c_f32_bf16 v84, v56, v88
    v_dot2c_f32_bf16 v86, v56, v56
    v_dot2c_f32_bf16 v85, v57, v88
    v_dot2c_f32_bf16 v87, v57, v57
    v_dot2c_f32_bf16 v84, v58, v88
    v_dot2c_f32_bf16 v86, v58, v58
    v_dot2c_f32_bf16 v85, v59, v88
    v_dot2c_f32_bf16 v87, v59, v59
    s_waitcnt lgkmcnt(5)
    v_dot2c_f32_bf16 v84, v60, v88
    v_dot2c_f32_bf16 v86, v60, v60
    v_dot2c_f32_bf16 v85, v61, v88
    v_dot2c_f32_bf16 v87, v61, v61
    v_dot2c_f32_bf16 v84, v62, v88
    v_dot2c_f32_bf16 v86, v62, v62
    v_dot2c_f32_bf16 v85, v63, v88
    v_dot2c_f32_bf16 v87, v63, v63
    s_waitcnt lgkmcnt(4)
    v_dot2c_f32_bf16 v84, v64, v88
    v_dot2c_f32_bf16 v86, v64, v64
    v_dot2c_f32_bf16 v85, v65, v88
    v_dot2c_f32_bf16 v87, v65, v65
    v_dot2c_f32_bf16 v84, v66, v88
    v_dot2c_f32_bf16 v86, v66, v66
    v_dot2c_f32_bf16 v85, v67, v88
    v_dot2c_f32_bf16 v87, v67, v67
    s_waitcnt lgkmcnt(3)
    v_dot2c_f32_bf16 v84, v68, v88
    v_dot2c_f32_bf16 v86, v68, v68
    v_dot2c_f32_bf16 v85, v69, v88
    v_dot2c_f32_bf16 v87, v69, v69
    v_dot2c_f32_bf16 v84, v70, v88
    v_dot2c_f32_bf16 v86, v70, v70
    v_dot2c_f32_bf16 v85, v71, v88
    v_dot2c_f32_bf16 v87, v71, v71
    s_waitcnt lgkmcnt(2)
    v_dot2c_f32_bf16 v84, v72, v88
    v_dot2c_f32_bf16 v86, v72, v72
    v_dot2c_f32_bf16 v85, v73, v88
    v_dot2c_f32_bf16 v87, v73, v73
    v_dot2c_f32_bf16 v84, v74, v88
    v_dot2c_f32_bf16 v86, v74, v74
    v_dot2c_f32_bf16 v85, v75, v88
    v_dot2c_f32_bf16 v87, v75, v75
    s_waitcnt lgkmcnt(1)
    v_dot2c_f32_bf16 v84, v76, v88
    v_dot2c_f32_bf16 v86, v76, v76
    v_dot2c_f32_bf16 v85, v77, v88
    v_dot2c_f32_bf16 v87, v77, v77
    v_dot2c_f32_bf16 v84, v78, v88
    v_dot2c_f32_bf16 v86, v78, v78
    v_dot2c_f32_bf16 v85, v79, v88
    v_dot2c_f32_bf16 v87, v79, v79
    s_waitcnt lgkmcnt(0)
    v_dot2c_f32_bf16 v84, v80, v88
    v_dot2c_f32_bf16 v86, v80, v80
    v_dot2c_f32_bf16 v85, v81, v88
    v_dot2c_f32_bf16 v87, v81, v81
    v_dot2c_f32_bf16 v84, v82, v88
    v_dot2c_f32_bf16 v86, v82, v82
    v_dot2c_f32_bf16 v85, v83, v88
    v_dot2c_f32_bf16 v87, v83, v83
    s_nop 2
    v_add_f32 v42, v84, v85
    v_add_f32 v43, v86, v87
    s_nop 1
    v_add_f32_dpp v42, v42, v42 quad_perm:[1,0,3,2] row_mask:0xf bank_mask:0xf
    v_add_f32_dpp v43, v43, v43 quad_perm:[1,0,3,2] row_mask:0xf bank_mask:0xf
    s_nop 1
    v_add_f32_dpp v42, v42, v42 quad_perm:[2,3,0,1] row_mask:0xf bank_mask:0xf
    v_add_f32_dpp v43, v43, v43 quad_perm:[2,3,0,1] row_mask:0xf bank_mask:0xf
    s_nop 1
    v_add_f32_dpp v42, v42, v42 row_half_mirror row_mask:0xf bank_mask:0xf
    v_add_f32_dpp v43, v43, v43 row_half_mirror row_mask:0xf bank_mask:0xf
    v_mul_f32 v42, 0x3b000000, v42
    v_mul_f32 v43, 0x3b000000, v43
    v_fma_f32 v43, -v42, v42, v43
    v_max_f32 v43, 0, v43
    v_add_f32 v43, 0x3727c5ac, v43
    v_rsq_f32 v43, v43
    s_barrier
    s_barrier
    s_barrier
    s_barrier
    s_barrier
    s_cmp_lg_u32 s50, 7
    s_cbranch_scc1 L5
    s_waitcnt vmcnt(0)
    v_mov_b32 v16, 1
    v_mov_b32 v17, 0
    s_and_b32 s60, s2, 63
    s_lshl_b32 s60, s60, 2
    s_mov_b64 exec, 1
    buffer_atomic_add v16, v17, s[44:47], s60 offen sc1
    s_mov_b64 exec, -1
L5:
    s_barrier
    s_barrier
    s_barrier
    ds_write_b32 v40, v42
    ds_write_b32 v40, v43 offset:256
    s_waitcnt lgkmcnt(0)
    s_barrier
    s_barrier
    v_lshlrev_b32 v41, 2, v1
    buffer_load_dword v18, v41, s[44:47], 0 offen sc1
    s_lshl_b32 s60, s2, 1
    s_add_u32 s60, s60, s50
    s_sub_u32 s60, s60, 6
    s_mul_i32 s61, s60, 14336
    v_min_u32 v49, 55, v1
    v_lshlrev_b32 v49, 7, v49
    buffer_load_dword v141, v49, s[24:27], s61 offen
    s_add_u32 s61, s61, 7168
    buffer_load_dword v142, v49, s[24:27], s61 offen
    s_lshl_b32 s61, s60, 10
    v_and_b32 v49, 0x380, v49
    buffer_load_dword v143, v49, s[20:23], s61 offen
    s_barrier
    s_barrier
    s_waitcnt vmcnt(3)
    s_cmp_lg_u32 s50, 6
    s_cbranch_scc1 L6
    s_mov_b32 s61, 200000
L7:
    v_cmp_gt_u32 vcc, 4, v18
    s_cbranch_vccz L8
    buffer_load_dword v18, v41, s[44:47], 0 offen sc1
    s_waitcnt vmcnt(0)
    s_sub_u32 s61, s61, 1
    s_cmp_lg_u32 s61, 0
    s_cbranch_scc1 L7
L8:
    s_mov_b64 exec, -1
L6:
    s_barrier
    s_cmp_lg_u32 s50, 6
    s_cbranch_scc1 L9
    s_lshr_b32 s60, s48, 2
    s_lshl_b32 s60, s60, 3
    s_add_u32 s60, s60, s49
    s_lshl_b32 s60, s60, 7
    s_add_u32 s60, s60, 40960
    s_add_u32 s60, s60, s53
    s_and_b32 s61, s48, 3
    s_lshl_b32 s61, s61, 4
    s_add_u32 s60, s60, s61
    v_mov_b32 v19, 1
    s_mov_b64 exec, 1
    s_cmp_eq_u32 s56, 1
    s_cbranch_scc1 L10
    buffer_store_dword v19, v4, s[16:19], s60 offen sc1
    s_branch L11
L10:
    buffer_store_dword v19, v4, s[16:19], s60 offen
L11:
    s_mov_b64 exec, -1
    s_lshl_b32 s60, s49, 10
    s_add_u32 s60, s60, 0
    s_add_u32 s60, s60, s53
    v_mov_b32 v16, 1
    v_lshlrev_b32 v17, 7, v1
    s_mov_b64 exec, 255
    buffer_atomic_add v16, v17, s[16:19], s60 offen sc1
    s_mov_b64 exec, -1
L9:
    s_branch L_p1_join
L_p1_stats0:
    s_waitcnt vmcnt(0)
    s_add_u32 s60, s50, s49
    s_and_b32 s60, s60, 7
    s_lshl_b32 s61, s60, 10
    v_add_u32 v126, s61, v4
    ds_read_b128 v[48:51], v126 offset:0
    ds_read_b128 v[52:55], v126 offset:8192
    ds_read_b128 v[56:59], v126 offset:16384
    ds_read_b128 v[60:63], v126 offset:24576
    ds_read_b128 v[64:67], v126 offset:32768
    ds_read_b128 v[68:71], v126 offset:40960
    ds_read_b128 v[72:75], v126 offset:49152
    ds_read_b128 v[76:79], v126 offset:57344
    v_mov_b32 v116, 0
    v_mov_b32 v117, 0
    v_mov_b32 v118, 0
    v_mov_b32 v119, 0
    v_mov_b32 v120, 0x3f803f80
    s_lshl_b32 s60, s60, 5
    s_add_u32 s60, s60, 106496
    v_lshrrev_b32 v126, 3, v1
    v_lshlrev_b32 v126, 2, v126
    v_add_u32 v126, s60, v126
    s_waitcnt lgkmcnt(7)
    v_dot2c_f32_bf16 v116, v48, v120
    v_dot2c_f32_bf16 v118, v48, v48
    v_dot2c_f32_bf16 v117, v49, v120
    v_dot2c_f32_bf16 v119, v49, v49
    v_dot2c_f32_bf16 v116, v50, v120
    v_dot2c_f32_bf16 v118, v50, v50
    v_dot2c_f32_bf16 v117, v51, v120
    v_dot2c_f32_bf16 v119, v51, v51
    s_waitcnt lgkmcnt(6)
    v_dot2c_f32_bf16 v116, v52, v120
    v_dot2c_f32_bf16 v118, v52, v52
    v_dot2c_f32_bf16 v117, v53, v120
    v_dot2c_f32_bf16 v119, v53, v53
    v_dot2c_f32_bf16 v116, v54, v120
    v_dot2c_f32_bf16 v118, v54, v54
    v_dot2c_f32_bf16 v117, v55, v120
    v_dot2c_f32_bf16 v119, v55, v55
    s_waitcnt lgkmcnt(5)
    v_dot2c_f32_bf16 v116, v56, v120
    v_dot2c_f32_bf16 v118, v56, v56
    v_dot2c_f32_bf16 v117, v57, v120
    v_dot2c_f32_bf16 v119, v57, v57
    v_dot2c_f32_bf16 v116, v58, v120
    v_dot2c_f32_bf16 v118, v58, v58
    v_dot2c_f32_bf16 v117, v59, v120
    v_dot2c_f32_bf16 v119, v59, v59
    s_waitcnt lgkmcnt(4)
    v_dot2c_f32_bf16 v116, v60, v120
    v_dot2c_f32_bf16 v118, v60, v60
    v_dot2c_f32_bf16 v117, v61, v120
    v_dot2c_f32_bf16 v119, v61, v61
    v_dot2c_f32_bf16 v116, v62, v120
    v_dot2c_f32_bf16 v118, v62, v62
    v_dot2c_f32_bf16 v117, v63, v120
    v_dot2c_f32_bf16 v119, v63, v63
    s_waitcnt lgkmcnt(3)
    v_dot2c_f32_bf16 v116, v64, v120
    v_dot2c_f32_bf16 v118, v64, v64
    v_dot2c_f32_bf16 v117, v65, v120
    v_dot2c_f32_bf16 v119, v65, v65
    v_dot2c_f32_bf16 v116, v66, v120
    v_dot2c_f32_bf16 v118, v66, v66
    v_dot2c_f32_bf16 v117, v67, v120
    v_dot2c_f32_bf16 v119, v67, v67
    s_waitcnt lgkmcnt(2)
    v_dot2c_f32_bf16 v116, v68, v120
    v_dot2c_f32_bf16 v118, v68, v68
    v_dot2c_f32_bf16 v117, v69, v120
    v_dot2c_f32_bf16 v119, v69, v69
    v_dot2c_f32_bf16 v116, v70, v120
    v_dot2c_f32_bf16 v118, v70, v70
    v_dot2c_f32_bf16 v117, v71, v120
    v_dot2c_f32_bf16 v119, v71, v71
    s_waitcnt lgkmcnt(1)
    v_dot2c_f32_bf16 v116, v72, v120
    v_dot2c_f32_bf16 v118, v72, v72
    v_dot2c_f32_bf16 v117, v73, v120
    v_dot2c_f32_bf16 v119, v73, v73
    v_dot2c_f32_bf16 v116, v74, v120
    v_dot2c_f32_bf16 v118, v74, v74
    v_dot2c_f32_bf16 v117, v75, v120
    v_dot2c_f32_bf16 v119, v75, v75
    s_waitcnt lgkmcnt(0)
    v_dot2c_f32_bf16 v116, v76, v120
    v_dot2c_f32_bf16 v118, v76, v76
    v_dot2c_f32_bf16 v117, v77, v120
    v_dot2c_f32_bf16 v119, v77, v77
    v_dot2c_f32_bf16 v116, v78, v120
    v_dot2c_f32_bf16 v118, v78, v78
    v_dot2c_f32_bf16 v117, v79, v120
    v_dot2c_f32_bf16 v119, v79, v79
    s_nop 2
    v_add_f32 v124, v116, v117
    v_add_f32 v125, v118, v119
    s_nop 1
    v_add_f32_dpp v124, v124, v124 quad_perm:[1,0,3,2] row_mask:0xf bank_mask:0xf
    v_add_f32_dpp v125, v125, v125 quad_perm:[1,0,3,2] row_mask:0xf bank_mask:0xf
    s_nop 1
    v_add_f32_dpp v124, v124, v124 quad_perm:[2,3,0,1] row_mask:0xf bank_mask:0xf
    v_add_f32_dpp v125, v125, v125 quad_perm:[2,3,0,1] row_mask:0xf bank_mask:0xf
    s_nop 1
    v_add_f32_dpp v124, v124, v124 row_half_mirror row_mask:0xf bank_mask:0xf
    v_add_f32_dpp v125, v125, v125 row_half_mirror row_mask:0xf bank_mask:0xf
    v_mul_f32 v124, 0x3b000000, v124
    v_mul_f32 v125, 0x3b000000, v125
    v_fma_f32 v125, -v124, v124, v125
    v_max_f32 v125, 0, v125
    v_add_f32 v125, 0x3727c5ac, v125
    v_rsq_f32 v125, v125
    s_branch L18
Lcs19:
    v_smfmac_f32_16x16x64_bf16 v[24:27], v[32:35], a[4:11], v21
    v_smfmac_f32_16x16x64_bf16 v[24:27], v[32:35], a[16:23], v21
    v_smfmac_f32_16x16x64_bf16 v[24:27], v[32:35], a[28:35], v21
    v_smfmac_f32_16x16x64_bf16 v[24:27], v[32:35], a[40:47], v21
    s_branch Lcr20
Lcs21:
    v_smfmac_f32_16x16x64_bf16 v[24:27], v[32:35], a[68:75], v21
    v_smfmac_f32_16x16x64_bf16 v[24:27], v[32:35], a[80:87], v21
    v_smfmac_f32_16x16x64_bf16 v[24:27], v[32:35], a[92:99], v21
    v_smfmac_f32_16x16x64_bf16 v[24:27], v[32:35], a[104:111], v21
    s_branch Lcr22
Lcs23:
    v_smfmac_f32_16x16x64_bf16 v[24:27], v[32:35], a[4:11], v21
    v_smfmac_f32_16x16x64_bf16 v[24:27], v[32:35], a[16:23], v21
    v_smfmac_f32_16x16x64_bf16 v[24:27], v[32:35], a[28:35], v21
    v_smfmac_f32_16x16x64_bf16 v[24:27], v[32:35], a[40:47], v21
    s_branch Lcr24
Lcs25:
    v_smfmac_f32_16x16x64_bf16 v[24:27], v[32:35], a[68:75], v21
    v_smfmac_f32_16x16x64_bf16 v[24:27], v[32:35], a[80:87], v21
    v_smfmac_f32_16x16x64_bf16 v[24:27], v[32:35], a[92:99], v21
    v_smfmac_f32_16x16x64_bf16 v[24:27], v[32:35], a[104:111], v21
    s_branch Lcr26
Lcs27:
    v_smfmac_f32_16x16x64_bf16 v[24:27], v[32:35], a[4:11], v21
    v_smfmac_f32_16x16x64_bf16 v[24:27], v[32:35], a[16:23], v21
    v_smfmac_f32_16x16x64_bf16 v[24:27], v[32:35], a[28:35], v21
    v_smfmac_f32_16x16x64_bf16 v[24:27], v[32:35], a[40:47], v21
    s_branch Lcr28
Lcs29:
    v_smfmac_f32_16x16x64_bf16 v[24:27], v[32:35], a[68:75], v21
    v_smfmac_f32_16x16x64_bf16 v[24:27], v[32:35], a[80:87], v21
    v_smfmac_f32_16x16x64_bf16 v[24:27], v[32:35], a[92:99], v21
    v_smfmac_f32_16x16x64_bf16 v[24:27], v[32:35], a[104:111], v21
    s_branch Lcr30
Lcs31:
    v_smfmac_f32_16x16x64_bf16 v[24:27], v[32:35], a[4:11], v21
    v_smfmac_f32_16x16x64_bf16 v[24:27], v[32:35], a[16:23], v21
    v_smfmac_f32_16x16x64_bf16 v[24:27], v[32:35], a[28:35], v21
    v_smfmac_f32_16x16x64_bf16 v[24:27], v[32:35], a[40:47], v21
    ds_write_b32 v126, v124
    ds_write_b32 v126, v125 offset:256
    s_branch Lcr32
Lcs33:
    v_smfmac_f32_16x16x64_bf16 v[24:27], v[32:35], a[68:75], v21
    v_smfmac_f32_16x16x64_bf16 v[24:27], v[32:35], a[80:87], v21
    v_smfmac_f32_16x16x64_bf16 v[24:27], v[32:35], a[92:99], v21
    v_smfmac_f32_16x16x64_bf16 v[24:27], v[32:35], a[104:111], v21
    s_nop 7
    v_add_f32 v16, v24, v25
    v_add_f32 v17, v26, v27
    s_branch Lcr34
Lcs35:
    v_smfmac_f32_16x16x64_bf16 v[28:31], v[32:35], a[8:15], v21
    v_smfmac_f32_16x16x64_bf16 v[28:31], v[32:35], a[24:31], v21
    v_smfmac_f32_16x16x64_bf16 v[28:31], v[32:35], a[40:47], v21
    v_smfmac_f32_16x16x64_bf16 v[28:31], v[32:35], a[56:63], v21
    s_branch Lcr36
Lcs37:
    v_smfmac_f32_16x16x64_bf16 v[28:31], v[32:35], a[72:79], v21
    v_smfmac_f32_16x16x64_bf16 v[28:31], v[32:35], a[88:95], v21
    v_smfmac_f32_16x16x64_bf16 v[28:31], v[32:35], a[104:111], v21
    v_smfmac_f32_16x16x64_bf16 v[28:31], v[32:35], v[104:111], v21
    s_branch Lcr38
Lcs39:
    v_smfmac_f32_16x16x64_bf16 v[28:31], v[32:35], a[8:15], v21
    v_smfmac_f32_16x16x64_bf16 v[28:31], v[32:35], a[24:31], v21
    v_smfmac_f32_16x16x64_bf16 v[28:31], v[32:35], a[40:47], v21
    v_smfmac_f32_16x16x64_bf16 v[28:31], v[32:35], a[56:63], v21
    s_branch Lcr40
Lcs41:
    v_smfmac_f32_16x16x64_bf16 v[28:31], v[32:35], a[72:79], v21
    v_smfmac_f32_16x16x64_bf16 v[28:31], v[32:35], a[88:95], v21
    v_smfmac_f32_16x16x64_bf16 v[28:31], v[32:35], a[104:111], v21
    v_smfmac_f32_16x16x64_bf16 v[28:31], v[32:35], v[104:111], v21
    s_nop 7
    v_add_f32 v28, v28, v29
    v_add_f32 v30, v30, v31
    v_add_f32 v18, v28, v30
    s_branch Lcr42
L_layer:
    s_cmp_lt_u32 s50, 4
    s_cbranch_scc1 L_p1_cons
    s_sub_u32 s63, s50, 4
    s_mul_i32 s62, s63, 49152
    s_lshl_b32 s60, s49, 7
    s_add_u32 s62, s62, s60
    s_lshl_b32 s60, s63, 4
    v_lshrrev_b32 v40, 2, v1
    v_add_u32 v40, s60, v40
    s_lshl_b32 s63, s63, 11
    s_add_u32 s63, s63, 65536
    v_and_b32 v41, 3, v1
    v_lshlrev_b32 v41, 11, v41
    v_lshl_add_u32 v41, v40, 3, v41
    s_cmp_lg_u32 s50, 4
    s_cbranch_scc1 L12
    s_lshl_b32 s60, s48, 7
    s_add_u32 s60, s60, 28672
    s_add_u32 s60, s60, s53
    s_mov_b64 exec, 255
    s_mov_b32 s61, 200000
L13:
    buffer_load_dword v16, v4, s[16:19], s60 offen sc1
    s_waitcnt vmcnt(0)
    v_cmp_ne_u32 vcc, 1, v16
    s_cbranch_vccz L14
    s_sub_u32 s61, s61, 1
    s_cmp_lg_u32 s61, 0
    s_cbranch_scc1 L13
L14:
    s_mov_b64 exec, -1
L12:
    s_mov_b32 s53, 33619968
    s_barrier
    s_lshl_b32 s60, s48, 16
    s_add_u32 s61, s50, s49
    s_and_b32 s61, s61, 7
    s_lshl_b32 s61, s61, 10
    s_add_u32 m0, s61, 0
    s_nop 0
    buffer_load_dwordx4 v15, s[8:11], s60 offen offset:0 sc1 lds
    s_add_u32 m0, s61, 8064
    s_nop 0
    buffer_load_dwordx4 v15, s[8:11], s60 offen offset:128 sc1 lds
    s_barrier
    s_lshl_b32 s60, s48, 16
    s_add_u32 s61, s50, s49
    s_and_b32 s61, s61, 7
    s_lshl_b32 s61, s61, 10
    s_add_u32 m0, s61, 16128
    s_nop 0
    buffer_load_dwordx4 v15, s[8:11], s60 offen offset:256 sc1 lds
    s_add_u32 m0, s61, 24192
    s_nop 0
    buffer_load_dwordx4 v15, s[8:11], s60 offen offset:384 sc1 lds
    s_add_u32 m0, s61, 32256
    s_nop 0
    buffer_load_dwordx4 v15, s[8:11], s60 offen offset:512 sc1 lds
    s_add_u32 m0, s61, 40320
    s_nop 0
    buffer_load_dwordx4 v15, s[8:11], s60 offen offset:640 sc1 lds
    s_add_u32 m0, s61, 48384
    s_nop 0
    buffer_load_dwordx4 v15, s[8:11], s60 offen offset:768 sc1 lds
    s_add_u32 m0, s61, 56448
    s_nop 0
    buffer_load_dwordx4 v15, s[8:11], s60 offen offset:896 sc1 lds
    s_lshl_b32 s60, s48, 13
    s_add_u32 s60, s60, 12845056
    buffer_load_dwordx2 v[48:49], v41, s[16:19], s60 offen sc1
    buffer_load_dwordx2 v[50:51], v41, s[16:19], s60 offen offset:1024 sc1
    s_waitcnt vmcnt(9)
    s_barrier
    s_mov_b32 s61, s62
    s_add_u32 m0, s63, 0
    s_add_u32 s60, s61, 591872
    buffer_load_dwordx4 v14, s[12:15], s60 offen lds
    s_add_u32 m0, s63, 1024
    s_add_u32 s60, s61, 616448
    buffer_load_dwordx4 v14, s[12:15], s60 offen lds
    s_mov_b32 s61, s62
    s_add_u32 m0, s63, 8192
    s_add_u32 s60, s61, 787456
    buffer_load_dwordx4 v14, s[12:15], s60 offen lds
    s_add_u32 m0, s63, 9216
    s_add_u32 s60, s61, 812032
    buffer_load_dwordx4 v14, s[12:15], s60 offen lds
    s_mov_b32 s61, s62
    s_add_u32 m0, s63, 16384
    s_add_u32 s60, s61, 788480
    buffer_load_dwordx4 v14, s[12:15], s60 offen lds
    s_add_u32 m0, s63, 17408
    s_add_u32 s60, s61, 813056
    buffer_load_dwordx4 v14, s[12:15], s60 offen lds
    s_waitcnt vmcnt(14)
    s_barrier
    s_mov_b32 s61, s62
    s_add_u32 m0, s63, 24576
    s_add_u32 s60, s61, 984064
    buffer_load_dwordx4 v14, s[12:15], s60 offen lds
    s_add_u32 m0, s63, 25600
    s_add_u32 s60, s61, 1008640
    buffer_load_dwordx4 v14, s[12:15], s60 offen lds
    s_mov_b32 s61, s62
    s_add_u32 m0, s63, 32768
    s_add_u32 s60, s61, 985088
    buffer_load_dwordx4 v14, s[12:15], s60 offen lds
    s_add_u32 m0, s63, 33792
    s_add_u32 s60, s61, 1009664
    buffer_load_dwordx4 v14, s[12:15], s60 offen lds
    s_waitcnt vmcnt(17)
    s_barrier
    s_mov_b32 s61, s62
    s_add_u32 m0, s63, 40960
    s_add_u32 s60, s61, 1180672
    buffer_load_dwordx4 v14, s[12:15], s60 offen lds
    s_add_u32 m0, s63, 41984
    s_add_u32 s60, s61, 1205248
    buffer_load_dwordx4 v14, s[12:15], s60 offen lds
    s_mov_b32 s61, s62
    s_add_u32 m0, s63, 49152
    s_add_u32 s60, s61, 1181696
    buffer_load_dwordx4 v14, s[12:15], s60 offen lds
    s_add_u32 m0, s63, 50176
    s_add_u32 s60, s61, 1206272
    buffer_load_dwordx4 v14, s[12:15], s60 offen lds
    s_waitcnt vmcnt(12)
    s_barrier
    s_mov_b32 s61, s62
    s_add_u32 m0, s63, 57344
    s_add_u32 s60, s61, 1377280
    buffer_load_dwordx4 v14, s[12:15], s60 offen lds
    s_add_u32 m0, s63, 58368
    s_add_u32 s60, s61, 1401856
    buffer_load_dwordx4 v14, s[12:15], s60 offen lds
    s_mov_b32 s61, s62
    s_add_u32 m0, s63, 65536
    s_add_u32 s60, s61, 1378304
    buffer_load_dwordx4 v14, s[12:15], s60 offen lds
    s_add_u32 m0, s63, 66560
    s_add_u32 s60, s61, 1402880
    buffer_load_dwordx4 v14, s[12:15], s60 offen lds
    s_waitcnt vmcnt(12)
    s_barrier
    s_mov_b32 s61, s62
    s_add_u32 m0, s63, 73728
    s_add_u32 s60, s61, 0
    buffer_load_dwordx4 v14, s[12:15], s60 offen lds
    s_add_u32 m0, s63, 74752
    s_add_u32 s60, s61, 24576
    buffer_load_dwordx4 v14, s[12:15], s60 offen lds
    s_waitcnt vmcnt(10)
    s_barrier
    s_mov_b32 s61, s62
    s_add_u32 m0, s63, 81920
    s_add_u32 s60, s61, 196608
    buffer_load_dwordx4 v14, s[12:15], s60 offen lds
    s_add_u32 m0, s63, 82944
    s_add_u32 s60, s61, 221184
    buffer_load_dwordx4 v14, s[12:15], s60 offen lds
    s_waitcnt vmcnt(8)
    s_barrier
    s_mov_b32 s61, s62
    s_add_u32 m0, s63, 90112
    s_add_u32 s60, s61, 393216
    buffer_load_dwordx4 v14, s[12:15], s60 offen lds
    s_add_u32 m0, s63, 91136
    s_add_u32 s60, s61, 417792
    buffer_load_dwordx4 v14, s[12:15], s60 offen lds
    s_mov_b32 s61, s62
    s_add_u32 m0, s63, 0
    s_add_u32 s60, s61, 589824
    buffer_load_dwordx4 v14, s[12:15], s60 offen lds
    s_add_u32 m0, s63, 1024
    s_add_u32 s60, s61, 614400
    buffer_load_dwordx4 v14, s[12:15], s60 offen lds
    v_add_f32 v42, v48, v50
    v_add_f32 v44, v49, v51
    s_nop 1
    v_add_f32_dpp v42, v42, v42 quad_perm:[1,0,3,2] row_mask:0xf bank_mask:0xf
    v_add_f32_dpp v44, v44, v44 quad_perm:[1,0,3,2] row_mask:0xf bank_mask:0xf
    s_nop 1
    v_add_f32_dpp v42, v42, v42 quad_perm:[2,3,0,1] row_mask:0xf bank_mask:0xf
    v_add_f32_dpp v44, v44, v44 quad_perm:[2,3,0,1] row_mask:0xf bank_mask:0xf
    v_mul_f32 v42, 0x3b000000, v42
    v_mul_f32 v44, 0x3b000000, v44
    v_fma_f32 v44, -v42, v42, v44
    v_max_f32 v44, 0, v44
    v_add_f32 v44, 0x3727c5ac, v44
    v_rsq_f32 v44, v44
    v_lshlrev_b32 v40, 2, v40
    v_add_u32 v40, 106496, v40
    s_waitcnt vmcnt(8)
    s_barrier
    ds_write_b32 v40, v42
    ds_write_b32 v40, v44 offset:256
    s_mov_b32 s61, s62
    s_add_u32 m0, s63, 8192
    s_add_u32 s60, s61, 786432
    buffer_load_dwordx4 v14, s[12:15], s60 offen lds
    s_add_u32 m0, s63, 9216
    s_add_u32 s60, s61, 811008
    buffer_load_dwordx4 v14, s[12:15], s60 offen lds
    s_mov_b32 s61, s62
    s_add_u32 m0, s63, 16384
    s_add_u32 s60, s61, 983040
    buffer_load_dwordx4 v14, s[12:15], s60 offen lds
    s_add_u32 m0, s63, 17408
    s_add_u32 s60, s61, 1007616
    buffer_load_dwordx4 v14, s[12:15], s60 offen lds
    s_waitcnt vmcnt(8)
    s_waitcnt lgkmcnt(0)
    s_barrier
    s_mov_b32 s61, s62
    s_add_u32 m0, s63, 24576
    s_add_u32 s60, s61, 1179648
    buffer_load_dwordx4 v14, s[12:15], s60 offen lds
    s_add_u32 m0, s63, 25600
    s_add_u32 s60, s61, 1204224
    buffer_load_dwordx4 v14, s[12:15], s60 offen lds
    s_mov_b32 s61, s62
    s_add_u32 m0, s63, 32768
    s_add_u32 s60, s61, 1376256
    buffer_load_dwordx4 v14, s[12:15], s60 offen lds
    s_add_u32 m0, s63, 33792
    s_add_u32 s60, s61, 1400832
    buffer_load_dwordx4 v14, s[12:15], s60 offen lds
    s_waitcnt vmcnt(8)
    s_barrier
    s_waitcnt vmcnt(4)
    s_barrier
    s_waitcnt vmcnt(0)
    s_barrier
    s_barrier
    s_cmp_lg_u32 s50, 4
    s_cbranch_scc1 L15
    s_lshr_b32 s60, s48, 2
    s_lshl_b32 s60, s60, 3
    s_add_u32 s60, s60, s49
    s_lshl_b32 s60, s60, 7
    s_add_u32 s60, s60, 40960
    s_add_u32 s60, s60, s53
    s_and_b32 s61, s48, 3
    s_lshl_b32 s61, s61, 4
    s_add_u32 s60, s60, s61
    v_mov_b32 v19, 1
    s_mov_b64 exec, 1
    s_cmp_eq_u32 s56, 1
    s_cbranch_scc1 L16
    buffer_store_dword v19, v4, s[16:19], s60 offen sc1
    s_branch L17
L16:
    buffer_store_dword v19, v4, s[16:19], s60 offen
L17:
    s_mov_b64 exec, -1
    s_lshl_b32 s60, s49, 10
    s_add_u32 s60, s60, 0
    s_add_u32 s60, s60, s53
    v_mov_b32 v16, 1
    v_lshlrev_b32 v17, 7, v1
    s_mov_b64 exec, 255
    buffer_atomic_add v16, v17, s[16:19], s60 offen sc1
    s_mov_b64 exec, -1
L15:
    s_branch L_p1_join
L_p1_cons:
    s_and_b32 s62, s50, 1
    s_lshr_b32 s63, s50, 1
    v_and_b32 v44, 31, v1
    s_lshl_b32 s60, s62, 5
    v_add_u32 v44, s60, v44
    v_lshlrev_b32 v38, 2, v44
    v_add_u32 v38, 106496, v38
    v_bfe_u32 v45, v1, 1, 3
    v_lshrrev_b32 v46, 5, v1
    v_xor_b32 v45, v45, v46
    v_lshlrev_b32 v45, 4, v45
    v_lshl_add_u32 v40, v44, 7, v45
    v_xor_b32 v41, 32, v40
    v_xor_b32 v42, 64, v40
    v_xor_b32 v43, 96, v40
    s_lshl_b32 s60, s62, 7
    s_add_u32 s60, s60, 106752
    v_lshlrev_b32 v37, 4, v46
    v_add_u32 v37, s60, v37
    v_lshrrev_b32 v46, 5, v1
    v_lshlrev_b32 v46, 3, v46
    v_bfe_u32 v47, v1, 2, 2
    v_add_u32 v46, v46, v47
    v_lshlrev_b32 v44, 7, v46
    v_lshrrev_b32 v47, 1, v47
    v_xor_b32 v47, s63, v47
    v_lshl_add_u32 v44, v47, 6, v44
    v_bfe_u32 v47, v1, 4, 1
    v_lshl_add_u32 v44, v47, 5, v44
    v_and_b32 v47, 3, v1
    v_lshl_add_u32 v44, v47, 3, v44
    v_add_u32 v44, 65536, v44
    v_add_u32 v45, 49152, v44
    v_lshrrev_b32 v46, 4, v1
    v_xor_b32 v46, v46, v1
    v_and_b32 v46, 2, v46
    v_and_b32 v47, 12, v1
    v_or_b32 v46, v46, v47
    v_mov_b32 v47, 0x3f803f80
    v_cmp_eq_u32 vcc, 0, v46
    s_nop 1
    v_cndmask_b32 v32, 0, v47, vcc
    v_cmp_eq_u32 vcc, 4, v46
    v_mov_b32 v33, v32
    s_nop 0
    v_cndmask_b32 v34, 0, v47, vcc
    v_mov_b32 v35, v34
    v_and_b32 v46, 1, v1
    v_mul_u32_u24 v46, 0xaaaa, v46
    v_or_b32 v21, 0x4444, v46
    v_lshl_add_u32 v21, v21, 16, v21
    s_lshl_b32 s68, s2, 2
    s_add_u32 s68, s68, s50
    s_lshl_b32 s68, s68, 10
    s_add_u32 s68, s68, 13631488
    v_mov_b32 v24, 0
    v_mov_b32 v25, 0
    v_mov_b32 v26, 0
    v_mov_b32 v27, 0
    v_mov_b32 v28, 0
    v_mov_b32 v29, 0
    v_mov_b32 v30, 0
    v_mov_b32 v31, 0
    s_lshl_b32 s64, s48, 1
    s_add_u32 s64, s64, s62
    s_lshl_b32 s65, s49, 2
    s_lshl_b32 s66, s63, 1
    s_add_u32 s65, s65, s66
    s_lshl_b32 s65, s65, 6
    s_add_u32 s65, s65, s64
    s_lshl_b32 s64, s65, 11
    s_add_u32 s64, s64, s52
    s_add_u32 s65, s64, 131072
    v_and_b32 v46, 0x33, v1
    v_bfe_u32 v47, v1, 2, 1
    v_lshl_add_u32 v46, v47, 3, v46
    v_bfe_u32 v47, v1, 3, 1
    v_lshl_add_u32 v46, v47, 2, v46
    v_lshlrev_b32 v46, 4, v46
    v_bfe_u32 v39, v1, 4, 1
    v_lshlrev_b32 v47, 17, v39
    v_lshrrev_b32 v39, 5, v1
    v_lshl_add_u32 v47, v39, 8, v47
    v_and_b32 v39, 15, v1
    v_lshl_add_u32 v47, v39, 4, v47
    s_cmp_eq_u32 s51, 0
    s_cbranch_scc1 L_p1_stats0
    s_mov_b32 s53, 33619968
    s_barrier
    s_lshl_b32 s60, s48, 16
    s_add_u32 s61, s50, s49
    s_and_b32 s61, s61, 7
    s_lshl_b32 s61, s61, 10
    s_add_u32 m0, s61, 0
    s_nop 0
    buffer_load_dwordx4 v15, s[8:11], s60 offen offset:0 sc1 lds
    s_add_u32 m0, s61, 8064
    s_nop 0
    buffer_load_dwordx4 v15, s[8:11], s60 offen offset:128 sc1 lds
    s_barrier
    s_lshl_b32 s60, s48, 16
    s_add_u32 s61, s50, s49
    s_and_b32 s61, s61, 7
    s_lshl_b32 s61, s61, 10
    s_add_u32 m0, s61, 16128
    s_nop 0
    buffer_load_dwordx4 v15, s[8:11], s60 offen offset:256 sc1 lds
    s_add_u32 m0, s61, 24192
    s_nop 0
    buffer_load_dwordx4 v15, s[8:11], s60 offen offset:384 sc1 lds
    s_add_u32 m0, s61, 32256
    s_nop 0
    buffer_load_dwordx4 v15, s[8:11], s60 offen offset:512 sc1 lds
    s_add_u32 m0, s61, 40320
    s_nop 0
    buffer_load_dwordx4 v15, s[8:11], s60 offen offset:640 sc1 lds
    s_add_u32 m0, s61, 48384
    s_nop 0
    buffer_load_dwordx4 v15, s[8:11], s60 offen offset:768 sc1 lds
    s_add_u32 m0, s61, 56448
    s_nop 0
    buffer_load_dwordx4 v15, s[8:11], s60 offen offset:896 sc1 lds
L18:
    buffer_load_dwordx4 v[16:19], v4, s[16:19], s68 offen sc1
    s_waitcnt vmcnt(8)
    s_barrier
    ds_read_b128 a[0:3], v40 offset:0
    ds_read_b64_tr_b16 a[4:5], v44 offset:40960
    ds_read_b64_tr_b16 a[6:7], v44 offset:41472
    ds_read_b64_tr_b16 a[8:9], v45 offset:0
    ds_read_b64_tr_b16 a[10:11], v45 offset:512
    ds_read_b128 a[12:15], v41 offset:0
    ds_read_b64_tr_b16 a[16:17], v44 offset:43008
    ds_read_b64_tr_b16 a[18:19], v44 offset:43520
    ds_read_b64_tr_b16 a[20:21], v45 offset:2048
    ds_read_b64_tr_b16 a[22:23], v45 offset:2560
    ds_read_b128 a[24:27], v42 offset:0
    ds_read_b64_tr_b16 a[28:29], v44 offset:45056
    ds_read_b64_tr_b16 a[30:31], v44 offset:45568
    ds_read_b64_tr_b16 a[32:33], v45 offset:4096
    ds_read_b64_tr_b16 a[34:35], v45 offset:4608
    ds_read_b128 a[36:39], v43 offset:0
    ds_read_b64_tr_b16 a[40:41], v44 offset:47104
    ds_read_b64_tr_b16 a[42:43], v44 offset:47616
    ds_read_b64_tr_b16 a[44:45], v45 offset:6144
    ds_read_b64_tr_b16 a[46:47], v45 offset:6656
    s_cmp_eq_u32 s51, 0
    s_cselect_b64 vcc, -1, 0
    s_waitcnt vmcnt(7) lgkmcnt(0)
    s_barrier
    s_cbranch_vccnz Lcs19
Lcr20:
    v_mfma_f32_32x32x16_bf16 v[48:63], a[4:7], a[0:3], 0
    ds_read_b128 a[64:67], v40 offset:8192
    ds_read_b64_tr_b16 a[68:69], v45 offset:8192
    ds_read_b64_tr_b16 a[70:71], v45 offset:8704
    ds_read_b64_tr_b16 a[72:73], v45 offset:16384
    v_mfma_f32_32x32x16_bf16 v[64:79], a[0:3], a[8:11], 0
    ds_read_b64_tr_b16 a[74:75], v45 offset:16896
    ds_read_b128 a[76:79], v41 offset:8192
    ds_read_b64_tr_b16 a[80:81], v45 offset:10240
    ds_read_b64_tr_b16 a[82:83], v45 offset:10752
    v_mfma_f32_32x32x16_bf16 v[48:63], a[16:19], a[12:15], v[48:63]
    ds_read_b64_tr_b16 a[84:85], v45 offset:18432
    ds_read_b64_tr_b16 a[86:87], v45 offset:18944
    ds_read_b128 a[88:91], v42 offset:8192
    ds_read_b64_tr_b16 a[92:93], v45 offset:12288
    v_mfma_f32_32x32x16_bf16 v[64:79], a[12:15], a[20:23], v[64:79]
    ds_read_b64_tr_b16 a[94:95], v45 offset:12800
    ds_read_b64_tr_b16 a[96:97], v45 offset:20480
    ds_read_b64_tr_b16 a[98:99], v45 offset:20992
    ds_read_b128 a[100:103], v43 offset:8192
    v_mfma_f32_32x32x16_bf16 v[48:63], a[28:31], a[24:27], v[48:63]
    ds_read_b64_tr_b16 a[104:105], v45 offset:14336
    ds_read_b64_tr_b16 a[106:107], v45 offset:14848
    ds_read_b64_tr_b16 a[108:109], v45 offset:22528
    ds_read_b64_tr_b16 a[110:111], v45 offset:23040
    v_mfma_f32_32x32x16_bf16 v[64:79], a[24:27], a[32:35], v[64:79]
    v_mfma_f32_32x32x16_bf16 v[48:63], a[40:43], a[36:39], v[48:63]
    s_waitcnt vmcnt(6) lgkmcnt(0)
    s_barrier
    v_mfma_f32_32x32x16_bf16 v[64:79], a[36:39], a[44:47], v[64:79]
    s_cbranch_vccnz Lcs21
Lcr22:
    v_mfma_f32_32x32x16_bf16 v[48:63], a[68:71], a[64:67], v[48:63]
    ds_read_b128 a[0:3], v40 offset:16384
    ds_read_b64_tr_b16 a[4:5], v45 offset:24576
    ds_read_b64_tr_b16 a[6:7], v45 offset:25088
    ds_read_b64_tr_b16 a[8:9], v45 offset:32768
    v_mfma_f32_32x32x16_bf16 v[64:79], a[64:67], a[72:75], v[64:79]
    ds_read_b64_tr_b16 a[10:11], v45 offset:33280
    ds_read_b128 a[12:15], v41 offset:16384
    ds_read_b64_tr_b16 a[16:17], v45 offset:26624
    ds_read_b64_tr_b16 a[18:19], v45 offset:27136
    v_mfma_f32_32x32x16_bf16 v[48:63], a[80:83], a[76:79], v[48:63]
    ds_read_b64_tr_b16 a[20:21], v45 offset:34816
    ds_read_b64_tr_b16 a[22:23], v45 offset:35328
    ds_read_b128 a[24:27], v42 offset:16384
    ds_read_b64_tr_b16 a[28:29], v45 offset:28672
    v_mfma_f32_32x32x16_bf16 v[64:79], a[76:79], a[84:87], v[64:79]
    ds_read_b64_tr_b16 a[30:31], v45 offset:29184
    ds_read_b64_tr_b16 a[32:33], v45 offset:36864
    ds_read_b64_tr_b16 a[34:35], v45 offset:37376
    ds_read_b128 a[36:39], v43 offset:16384
    v_mfma_f32_32x32x16_bf16 v[48:63], a[92:95], a[88:91], v[48:63]
    ds_read_b64_tr_b16 a[40:41], v45 offset:30720
    ds_read_b64_tr_b16 a[42:43], v45 offset:31232
    ds_read_b64_tr_b16 a[44:45], v45 offset:38912
    ds_read_b64_tr_b16 a[46:47], v45 offset:39424
    v_mfma_f32_32x32x16_bf16 v[64:79], a[88:91], a[96:99], v[64:79]
    v_mfma_f32_32x32x16_bf16 v[48:63], a[104:107], a[100:103], v[48:63]
    s_waitcnt vmcnt(5) lgkmcnt(0)
    s_barrier
    v_mfma_f32_32x32x16_bf16 v[64:79], a[100:103], a[108:111], v[64:79]
    s_cbranch_vccnz Lcs23
Lcr24:
    v_mfma_f32_32x32x16_bf16 v[48:63], a[4:7], a[0:3], v[48:63]
    ds_read_b128 a[64:67], v40 offset:24576
    ds_read_b64_tr_b16 a[68:69], v45 offset:40960
    ds_read_b64_tr_b16 a[70:71], v45 offset:41472
    ds_read_b64_tr_b16 a[72:73], v44 offset:0
    v_mfma_f32_32x32x16_bf16 v[64:79], a[0:3], a[8:11], v[64:79]
    ds_read_b64_tr_b16 a[74:75], v44 offset:512
    ds_read_b128 a[76:79], v41 offset:24576
    ds_read_b64_tr_b16 a[80:81], v45 offset:43008
    ds_read_b64_tr_b16 a[82:83], v45 offset:43520
    v_mfma_f32_32x32x16_bf16 v[48:63], a[16:19], a[12:15], v[48:63]
    ds_read_b64_tr_b16 a[84:85], v44 offset:2048
    ds_read_b64_tr_b16 a[86:87], v44 offset:2560
    ds_read_b128 a[88:91], v42 offset:24576
    ds_read_b64_tr_b16 a[92:93], v45 offset:45056
    v_mfma_f32_32x32x16_bf16 v[64:79], a[12:15], a[20:23], v[64:79]
    ds_read_b64_tr_b16 a[94:95], v45 offset:45568
    ds_read_b64_tr_b16 a[96:97], v44 offset:4096
    ds_read_b64_tr_b16 a[98:99], v44 offset:4608
    ds_read_b128 a[100:103], v43 offset:24576
    v_mfma_f32_32x32x16_bf16 v[48:63], a[28:31], a[24:27], v[48:63]
    ds_read_b64_tr_b16 a[104:105], v45 offset:47104
    ds_read_b64_tr_b16 a[106:107], v45 offset:47616
    ds_read_b64_tr_b16 a[108:109], v44 offset:6144
    ds_read_b64_tr_b16 a[110:111], v44 offset:6656
    v_mfma_f32_32x32x16_bf16 v[64:79], a[24:27], a[32:35], v[64:79]
    v_mfma_f32_32x32x16_bf16 v[48:63], a[40:43], a[36:39], v[48:63]
    s_waitcnt vmcnt(4) lgkmcnt(0)
    s_barrier
    v_mfma_f32_32x32x16_bf16 v[64:79], a[36:39], a[44:47], v[64:79]
    s_cbranch_vccnz Lcs25
Lcr26:
    v_mfma_f32_32x32x16_bf16 v[48:63], a[68:71], a[64:67], v[48:63]
    ds_read_b128 a[0:3], v40 offset:32768
    ds_read_b64_tr_b16 a[4:5], v44 offset:8192
    ds_read_b64_tr_b16 a[6:7], v44 offset:8704
    ds_read_b64_tr_b16 a[8:9], v44 offset:16384
    v_mfma_f32_32x32x16_bf16 v[64:79], a[64:67], a[72:75], v[64:79]
    ds_read_b64_tr_b16 a[10:11], v44 offset:16896
    ds_read_b128 a[12:15], v41 offset:32768
    ds_read_b64_tr_b16 a[16:17], v44 offset:10240
    ds_read_b64_tr_b16 a[18:19], v44 offset:10752
    v_mfma_f32_32x32x16_bf16 v[48:63], a[80:83], a[76:79], v[48:63]
    ds_read_b64_tr_b16 a[20:21], v44 offset:18432
    ds_read_b64_tr_b16 a[22:23], v44 offset:18944
    ds_read_b128 a[24:27], v42 offset:32768
    ds_read_b64_tr_b16 a[28:29], v44 offset:12288
    v_mfma_f32_32x32x16_bf16 v[64:79], a[76:79], a[84:87], v[64:79]
    ds_read_b64_tr_b16 a[30:31], v44 offset:12800
    ds_read_b64_tr_b16 a[32:33], v44 offset:20480
    ds_read_b64_tr_b16 a[34:35], v44 offset:20992
    ds_read_b128 a[36:39], v43 offset:32768
    v_mfma_f32_32x32x16_bf16 v[48:63], a[92:95], a[88:91], v[48:63]
    ds_read_b64_tr_b16 a[40:41], v44 offset:14336
    ds_read_b64_tr_b16 a[42:43], v44 offset:14848
    ds_read_b64_tr_b16 a[44:45], v44 offset:22528
    ds_read_b64_tr_b16 a[46:47], v44 offset:23040
    v_mfma_f32_32x32x16_bf16 v[64:79], a[88:91], a[96:99], v[64:79]
    v_mfma_f32_32x32x16_bf16 v[48:63], a[104:107], a[100:103], v[48:63]
    s_waitcnt vmcnt(3) lgkmcnt(0)
    s_barrier
    v_mfma_f32_32x32x16_bf16 v[64:79], a[100:103], a[108:111], v[64:79]
    s_cbranch_vccnz Lcs27
Lcr28:
    v_mfma_f32_32x32x16_bf16 v[48:63], a[4:7], a[0:3], v[48:63]
    ds_read_b128 a[64:67], v40 offset:40960
    ds_read_b64_tr_b16 a[68:69], v44 offset:24576
    ds_read_b64_tr_b16 a[70:71], v44 offset:25088
    ds_read_b64_tr_b16 a[72:73], v44 offset:32768
    v_mfma_f32_32x32x16_bf16 v[64:79], a[0:3], a[8:11], v[64:79]
    ds_read_b64_tr_b16 a[74:75], v44 offset:33280
    ds_read_b128 a[76:79], v41 offset:40960
    ds_read_b64_tr_b16 a[80:81], v44 offset:26624
    ds_read_b64_tr_b16 a[82:83], v44 offset:27136
    v_mfma_f32_32x32x16_bf16 v[48:63], a[16:19], a[12:15], v[48:63]
    ds_read_b64_tr_b16 a[84:85], v44 offset:34816
    ds_read_b64_tr_b16 a[86:87], v44 offset:35328
    ds_read_b128 a[88:91], v42 offset:40960
    ds_read_b64_tr_b16 a[92:93], v44 offset:28672
    v_mfma_f32_32x32x16_bf16 v[64:79], a[12:15], a[20:23], v[64:79]
    ds_read_b64_tr_b16 a[94:95], v44 offset:29184
    ds_read_b64_tr_b16 a[96:97], v44 offset:36864
    ds_read_b64_tr_b16 a[98:99], v44 offset:37376
    ds_read_b128 a[100:103], v43 offset:40960
    v_mfma_f32_32x32x16_bf16 v[48:63], a[28:31], a[24:27], v[48:63]
    ds_read_b64_tr_b16 a[104:105], v44 offset:30720
    ds_read_b64_tr_b16 a[106:107], v44 offset:31232
    ds_read_b64_tr_b16 a[108:109], v44 offset:38912
    ds_read_b64_tr_b16 a[110:111], v44 offset:39424
    v_mfma_f32_32x32x16_bf16 v[64:79], a[24:27], a[32:35], v[64:79]
    v_mfma_f32_32x32x16_bf16 v[48:63], a[40:43], a[36:39], v[48:63]
    s_waitcnt vmcnt(2) lgkmcnt(0)
    s_barrier
    v_mfma_f32_32x32x16_bf16 v[64:79], a[36:39], a[44:47], v[64:79]
    s_cbranch_vccnz Lcs29
Lcr30:
    v_mfma_f32_32x32x16_bf16 v[48:63], a[68:71], a[64:67], v[48:63]
    ds_read_b128 a[0:3], v40 offset:49152
    ds_read_b64_tr_b16 a[4:5], v44 offset:40960
    ds_read_b64_tr_b16 a[6:7], v44 offset:41472
    ds_read_b64_tr_b16 a[8:9], v45 offset:0
    v_mfma_f32_32x32x16_bf16 v[64:79], a[64:67], a[72:75], v[64:79]
    ds_read_b64_tr_b16 a[10:11], v45 offset:512
    ds_read_b128 a[12:15], v41 offset:49152
    ds_read_b64_tr_b16 a[16:17], v44 offset:43008
    ds_read_b64_tr_b16 a[18:19], v44 offset:43520
    v_mfma_f32_32x32x16_bf16 v[48:63], a[80:83], a[76:79], v[48:63]
    ds_read_b64_tr_b16 a[20:21], v45 offset:2048
    ds_read_b64_tr_b16 a[22:23], v45 offset:2560
    ds_read_b128 a[24:27], v42 offset:49152
    ds_read_b64_tr_b16 a[28:29], v44 offset:45056
    v_mfma_f32_32x32x16_bf16 v[64:79], a[76:79], a[84:87], v[64:79]
    ds_read_b64_tr_b16 a[30:31], v44 offset:45568
    ds_read_b64_tr_b16 a[32:33], v45 offset:4096
    ds_read_b64_tr_b16 a[34:35], v45 offset:4608
    ds_read_b128 a[36:39], v43 offset:49152
    v_mfma_f32_32x32x16_bf16 v[48:63], a[92:95], a[88:91], v[48:63]
    ds_read_b64_tr_b16 a[40:41], v44 offset:47104
    ds_read_b64_tr_b16 a[42:43], v44 offset:47616
    ds_read_b64_tr_b16 a[44:45], v45 offset:6144
    ds_read_b64_tr_b16 a[46:47], v45 offset:6656
    v_mfma_f32_32x32x16_bf16 v[64:79], a[88:91], a[96:99], v[64:79]
    v_mfma_f32_32x32x16_bf16 v[48:63], a[104:107], a[100:103], v[48:63]
    s_waitcnt vmcnt(1) lgkmcnt(0)
    s_barrier
    v_mfma_f32_32x32x16_bf16 v[64:79], a[100:103], a[108:111], v[64:79]
    s_cbranch_vccnz Lcs31
Lcr32:
    v_mfma_f32_32x32x16_bf16 v[48:63], a[4:7], a[0:3], v[48:63]
    ds_read_b128 a[64:67], v40 offset:57344
    ds_read_b64_tr_b16 a[68:69], v45 offset:8192
    ds_read_b64_tr_b16 a[70:71], v45 offset:8704
    ds_read_b64_tr_b16 a[72:73], v45 offset:16384
    v_mfma_f32_32x32x16_bf16 v[64:79], a[0:3], a[8:11], v[64:79]
    ds_read_b64_tr_b16 a[74:75], v45 offset:16896
    ds_read_b128 a[76:79], v41 offset:57344
    ds_read_b64_tr_b16 a[80:81], v45 offset:10240
    ds_read_b64_tr_b16 a[82:83], v45 offset:10752
    v_mfma_f32_32x32x16_bf16 v[48:63], a[16:19], a[12:15], v[48:63]
    ds_read_b64_tr_b16 a[84:85], v45 offset:18432
    ds_read_b64_tr_b16 a[86:87], v45 offset:18944
    ds_read_b128 a[88:91], v42 offset:57344
    ds_read_b64_tr_b16 a[92:93], v45 offset:12288
    v_mfma_f32_32x32x16_bf16 v[64:79], a[12:15], a[20:23], v[64:79]
    ds_read_b64_tr_b16 a[94:95], v45 offset:12800
    ds_read_b64_tr_b16 a[96:97], v45 offset:20480
    ds_read_b64_tr_b16 a[98:99], v45 offset:20992
    ds_read_b128 a[100:103], v43 offset:57344
    v_mfma_f32_32x32x16_bf16 v[48:63], a[28:31], a[24:27], v[48:63]
    ds_read_b64_tr_b16 a[104:105], v45 offset:14336
    ds_read_b64_tr_b16 a[106:107], v45 offset:14848
    ds_read_b64_tr_b16 a[108:109], v45 offset:22528
    ds_read_b64_tr_b16 a[110:111], v45 offset:23040
    v_mfma_f32_32x32x16_bf16 v[64:79], a[24:27], a[32:35], v[64:79]
    v_mfma_f32_32x32x16_bf16 v[48:63], a[40:43], a[36:39], v[48:63]
    s_waitcnt vmcnt(0) lgkmcnt(0)
    s_barrier
    v_mfma_f32_32x32x16_bf16 v[64:79], a[36:39], a[44:47], v[64:79]
    s_cbranch_vccnz Lcs33
Lcr34:
    v_mfma_f32_32x32x16_bf16 v[48:63], a[68:71], a[64:67], v[48:63]
    ds_read_b32 v36, v38
    ds_read_b32 v39, v38 offset:256
    ds_read_b128 v[128:131], v37 offset:0
    ds_read_b128 v[132:135], v37 offset:32
    ds_read_b128 v[136:139], v37 offset:64
    ds_read_b128 v[140:143], v37 offset:96
    v_mfma_f32_32x32x16_bf16 v[48:63], a[80:83], a[76:79], v[48:63]
    v_cvt_pk_bf16_f32 v24, v16, v16
    v_and_b32 v25, 0xffff0000, v24
    v_sub_f32 v25, v16, v25
    v_cvt_pk_bf16_f32 v25, v25, v25
    ds_read_b128 a[0:3], v40 offset:0
    ds_read_b64_tr_b16 a[8:9], v45 offset:24576
    ds_read_b64_tr_b16 a[10:11], v45 offset:25088
    v_mfma_f32_32x32x16_bf16 v[48:63], a[92:95], a[88:91], v[48:63]
    v_cvt_pk_bf16_f32 v26, v17, v17
    v_and_b32 v27, 0xffff0000, v26
    v_sub_f32 v27, v17, v27
    v_cvt_pk_bf16_f32 v27, v27, v27
    ds_read_b128 a[4:7], v41 offset:0
    ds_read_b64_tr_b16 a[12:13], v45 offset:26624
    ds_read_b64_tr_b16 a[14:15], v45 offset:27136
    v_mfma_f32_32x32x16_bf16 v[48:63], a[104:107], a[100:103], v[48:63]
    s_waitcnt lgkmcnt(10)
    v_sub_f32 v36, 0, v36
    v_cvt_pk_bf16_f32 v22, v36, v36
    v_and_b32 v23, 0xffff0000, v22
    v_sub_f32 v23, v36, v23
    v_cvt_pk_bf16_f32 v22, v36, v23
    v_mov_b32 v23, v22
    v_mfma_f32_32x32x16_bf16 v[64:79], a[64:67], a[72:75], v[64:79]
    ds_read_b128 a[16:19], v42 offset:0
    ds_read_b64_tr_b16 a[24:25], v45 offset:28672
    ds_read_b64_tr_b16 a[26:27], v45 offset:29184
    v_mfma_f32_32x32x8_bf16 v[48:63], v[24:25], v[22:23], v[48:63]
    ds_read_b128 a[20:23], v43 offset:0
    ds_read_b64_tr_b16 a[28:29], v45 offset:30720
    ds_read_b64_tr_b16 a[30:31], v45 offset:31232
    ds_read_b128 a[32:35], v40 offset:8192
    ds_read_b64_tr_b16 a[40:41], v45 offset:32768
    v_mfma_f32_32x32x16_bf16 v[64:79], a[76:79], a[84:87], v[64:79]
    ds_read_b64_tr_b16 a[42:43], v45 offset:33280
    ds_read_b128 a[36:39], v41 offset:8192
    ds_read_b64_tr_b16 a[44:45], v45 offset:34816
    ds_read_b64_tr_b16 a[46:47], v45 offset:35328
    ds_read_b128 a[48:51], v42 offset:8192
    v_mfma_f32_32x32x16_bf16 v[64:79], a[88:91], a[96:99], v[64:79]
    ds_read_b64_tr_b16 a[56:57], v45 offset:36864
    ds_read_b64_tr_b16 a[58:59], v45 offset:37376
    ds_read_b128 a[52:55], v43 offset:8192
    ds_read_b64_tr_b16 a[60:61], v45 offset:38912
    ds_read_b64_tr_b16 a[62:63], v45 offset:39424
    v_mfma_f32_32x32x16_bf16 v[64:79], a[100:103], a[108:111], v[64:79]
    v_mul_f32 v48, v48, v39
    v_mul_f32 v49, v49, v39
    v_mul_f32 v50, v50, v39
    v_mul_f32 v51, v51, v39
    v_mul_f32 v52, v52, v39
    v_mul_f32 v53, v53, v39
    v_mul_f32 v54, v54, v39
    v_mul_f32 v55, v55, v39
    v_mul_f32 v56, v56, v39
    v_mul_f32 v57, v57, v39
    v_mfma_f32_32x32x8_bf16 v[64:79], v[22:23], v[26:27], v[64:79]
    v_mul_f32 v58, v58, v39
    v_mul_f32 v59, v59, v39
    v_mul_f32 v60, v60, v39
    v_mul_f32 v61, v61, v39
    v_mul_f32 v62, v62, v39
    v_mul_f32 v63, v63, v39
    v_cvt_pk_bf16_f32 v112, v48, v49
    v_cvt_pk_bf16_f32 v113, v50, v51
    v_cvt_pk_bf16_f32 v114, v52, v53
    v_cvt_pk_bf16_f32 v115, v54, v55
    v_cvt_pk_bf16_f32 v116, v56, v57
    v_cvt_pk_bf16_f32 v117, v58, v59
    v_cvt_pk_bf16_f32 v118, v60, v61
    v_cvt_pk_bf16_f32 v119, v62, v63
    buffer_store_dwordx4 v[112:115], v46, s[16:19], s64 offen sc1
    buffer_store_dwordx4 v[116:119], v46, s[16:19], s65 offen sc1
    s_waitcnt lgkmcnt(15)
    v_mul_f32 v64, v64, v128
    v_mul_f32 v65, v65, v129
    v_mul_f32 v66, v66, v130
    v_mul_f32 v67, v67, v131
    v_mul_f32 v68, v68, v132
    v_mul_f32 v69, v69, v133
    v_mul_f32 v70, v70, v134
    v_mul_f32 v71, v71, v135
    v_mul_f32 v72, v72, v136
    v_mul_f32 v73, v73, v137
    v_mul_f32 v74, v74, v138
    v_mul_f32 v75, v75, v139
    v_mul_f32 v76, v76, v140
    v_mul_f32 v77, v77, v141
    v_mul_f32 v78, v78, v142
    v_mul_f32 v79, v79, v143
    v_cvt_pk_bf16_f32 v120, v64, v65
    v_cvt_pk_bf16_f32 v121, v66, v67
    v_cvt_pk_bf16_f32 v122, v68, v69
    v_cvt_pk_bf16_f32 v123, v70, v71
    v_cvt_pk_bf16_f32 v124, v72, v73
    v_cvt_pk_bf16_f32 v125, v74, v75
    v_cvt_pk_bf16_f32 v126, v76, v77
    v_cvt_pk_bf16_f32 v127, v78, v79
    buffer_store_dwordx4 v[120:123], v47, s[16:19], s64 offen offset:1024 sc1
    buffer_store_dwordx4 v[124:127], v47, s[16:19], s64 offen offset:1536 sc1
    s_waitcnt lgkmcnt(0)
    s_barrier
    s_cbranch_vccnz Lcs35
Lcr36:
    v_mfma_f32_32x32x16_bf16 v[80:95], a[8:11], a[0:3], 0
    ds_read_b128 a[64:67], v40 offset:16384
    ds_read_b64_tr_b16 a[72:73], v45 offset:40960
    ds_read_b64_tr_b16 a[74:75], v45 offset:41472
    ds_read_b128 a[68:71], v41 offset:16384
    ds_read_b64_tr_b16 a[76:77], v45 offset:43008
    v_mfma_f32_32x32x16_bf16 v[80:95], a[12:15], a[4:7], v[80:95]
    ds_read_b64_tr_b16 a[78:79], v45 offset:43520
    ds_read_b128 a[80:83], v42 offset:16384
    ds_read_b64_tr_b16 a[88:89], v45 offset:45056
    ds_read_b64_tr_b16 a[90:91], v45 offset:45568
    ds_read_b128 a[84:87], v43 offset:16384
    v_mfma_f32_32x32x16_bf16 v[80:95], a[24:27], a[16:19], v[80:95]
    ds_read_b64_tr_b16 a[92:93], v45 offset:47104
    ds_read_b64_tr_b16 a[94:95], v45 offset:47616
    ds_read_b128 a[96:99], v40 offset:24576
    ds_read_b64_tr_b16 a[104:105], v44 offset:0
    ds_read_b64_tr_b16 a[106:107], v44 offset:512
    v_mfma_f32_32x32x16_bf16 v[80:95], a[28:31], a[20:23], v[80:95]
    ds_read_b128 a[100:103], v41 offset:24576
    ds_read_b64_tr_b16 a[108:109], v44 offset:2048
    ds_read_b64_tr_b16 a[110:111], v44 offset:2560
    ds_read_b128 v[96:99], v42 offset:24576
    ds_read_b64_tr_b16 v[104:105], v44 offset:4096
    v_mfma_f32_32x32x16_bf16 v[80:95], a[40:43], a[32:35], v[80:95]
    ds_read_b64_tr_b16 v[106:107], v44 offset:4608
    ds_read_b128 v[100:103], v43 offset:24576
    ds_read_b64_tr_b16 v[108:109], v44 offset:6144
    ds_read_b64_tr_b16 v[110:111], v44 offset:6656
    v_mfma_f32_32x32x16_bf16 v[80:95], a[44:47], a[36:39], v[80:95]
    v_mfma_f32_32x32x16_bf16 v[80:95], a[56:59], a[48:51], v[80:95]
    s_waitcnt lgkmcnt(0)
    s_barrier
    v_mfma_f32_32x32x16_bf16 v[80:95], a[60:63], a[52:55], v[80:95]
    s_cbranch_vccnz Lcs37
Lcr38:
    v_mfma_f32_32x32x16_bf16 v[80:95], a[72:75], a[64:67], v[80:95]
    ds_read_b128 a[0:3], v40 offset:32768
    ds_read_b64_tr_b16 a[8:9], v44 offset:8192
    ds_read_b64_tr_b16 a[10:11], v44 offset:8704
    ds_read_b128 a[4:7], v41 offset:32768
    ds_read_b64_tr_b16 a[12:13], v44 offset:10240
    v_mfma_f32_32x32x16_bf16 v[80:95], a[76:79], a[68:71], v[80:95]
    ds_read_b64_tr_b16 a[14:15], v44 offset:10752
    ds_read_b128 a[16:19], v42 offset:32768
    ds_read_b64_tr_b16 a[24:25], v44 offset:12288
    ds_read_b64_tr_b16 a[26:27], v44 offset:12800
    ds_read_b128 a[20:23], v43 offset:32768
    v_mfma_f32_32x32x16_bf16 v[80:95], a[88:91], a[80:83], v[80:95]
    ds_read_b64_tr_b16 a[28:29], v44 offset:14336
    ds_read_b64_tr_b16 a[30:31], v44 offset:14848
    ds_read_b128 a[32:35], v40 offset:40960
    ds_read_b64_tr_b16 a[40:41], v44 offset:16384
    ds_read_b64_tr_b16 a[42:43], v44 offset:16896
    v_mfma_f32_32x32x16_bf16 v[80:95], a[92:95], a[84:87], v[80:95]
    ds_read_b128 a[36:39], v41 offset:40960
    ds_read_b64_tr_b16 a[44:45], v44 offset:18432
    ds_read_b64_tr_b16 a[46:47], v44 offset:18944
    ds_read_b128 a[48:51], v42 offset:40960
    ds_read_b64_tr_b16 a[56:57], v44 offset:20480
    v_mfma_f32_32x32x16_bf16 v[80:95], a[104:107], a[96:99], v[80:95]
    ds_read_b64_tr_b16 a[58:59], v44 offset:20992
    ds_read_b128 a[52:55], v43 offset:40960
    ds_read_b64_tr_b16 a[60:61], v44 offset:22528
    ds_read_b64_tr_b16 a[62:63], v44 offset:23040
    v_mfma_f32_32x32x16_bf16 v[80:95], a[108:111], a[100:103], v[80:95]
    v_mfma_f32_32x32x16_bf16 v[80:95], v[104:107], v[96:99], v[80:95]
    s_waitcnt lgkmcnt(0)
    s_barrier
    v_mfma_f32_32x32x16_bf16 v[80:95], v[108:111], v[100:103], v[80:95]
    s_cbranch_vccnz Lcs39
Lcr40:
    v_mfma_f32_32x32x16_bf16 v[80:95], a[8:11], a[0:3], v[80:95]
    ds_read_b128 a[64:67], v40 offset:49152
    ds_read_b64_tr_b16 a[72:73], v44 offset:24576
    ds_read_b64_tr_b16 a[74:75], v44 offset:25088
    ds_read_b128 a[68:71], v41 offset:49152
    ds_read_b64_tr_b16 a[76:77], v44 offset:26624
    v_mfma_f32_32x32x16_bf16 v[80:95], a[12:15], a[4:7], v[80:95]
    ds_read_b64_tr_b16 a[78:79], v44 offset:27136
    ds_read_b128 a[80:83], v42 offset:49152
    ds_read_b64_tr_b16 a[88:89], v44 offset:28672
    ds_read_b64_tr_b16 a[90:91], v44 offset:29184
    ds_read_b128 a[84:87], v43 offset:49152
    v_mfma_f32_32x32x16_bf16 v[80:95], a[24:27], a[16:19], v[80:95]
    ds_read_b64_tr_b16 a[92:93], v44 offset:30720
    ds_read_b64_tr_b16 a[94:95], v44 offset:31232
    ds_read_b128 a[96:99], v40 offset:57344
    ds_read_b64_tr_b16 a[104:105], v44 offset:32768
    ds_read_b64_tr_b16 a[106:107], v44 offset:33280
    v_mfma_f32_32x32x16_bf16 v[80:95], a[28:31], a[20:23], v[80:95]
    ds_read_b128 a[100:103], v41 offset:57344
    ds_read_b64_tr_b16 a[108:109], v44 offset:34816
    ds_read_b64_tr_b16 a[110:111], v44 offset:35328
    ds_read_b128 v[96:99], v42 offset:57344
    ds_read_b64_tr_b16 v[104:105], v44 offset:36864
    v_mfma_f32_32x32x16_bf16 v[80:95], a[40:43], a[32:35], v[80:95]
    ds_read_b64_tr_b16 v[106:107], v44 offset:37376
    ds_read_b128 v[100:103], v43 offset:57344
    ds_read_b64_tr_b16 v[108:109], v44 offset:38912
    ds_read_b64_tr_b16 v[110:111], v44 offset:39424
    v_mfma_f32_32x32x16_bf16 v[80:95], a[44:47], a[36:39], v[80:95]
    v_mfma_f32_32x32x16_bf16 v[80:95], a[56:59], a[48:51], v[80:95]
    s_waitcnt vmcnt(0) lgkmcnt(0)
    s_barrier
    v_mfma_f32_32x32x16_bf16 v[80:95], a[60:63], a[52:55], v[80:95]
    s_cbranch_vccnz Lcs41
Lcr42:
    v_mfma_f32_32x32x16_bf16 v[80:95], a[72:75], a[64:67], v[80:95]
    s_lshl_b32 s66, s63, 12
    s_lshl_b32 s67, s62, 10
    s_add_u32 s66, s66, s67
    s_add_u32 s66, s66, 155648
    v_add_u32 v46, s66, v4
    v_mfma_f32_32x32x16_bf16 v[80:95], a[76:79], a[68:71], v[80:95]
    v_cvt_pk_bf16_f32 v24, v18, v18
    v_and_b32 v25, 0xffff0000, v24
    v_sub_f32 v25, v18, v25
    v_cvt_pk_bf16_f32 v25, v25, v25
    v_mul_f32 v39, 0x3eb8aa3b, v39
    v_mfma_f32_32x32x16_bf16 v[80:95], a[88:91], a[80:83], v[80:95]
    v_mfma_f32_32x32x16_bf16 v[80:95], a[92:95], a[84:87], v[80:95]
    v_mfma_f32_32x32x16_bf16 v[80:95], a[104:107], a[96:99], v[80:95]
    v_mfma_f32_32x32x16_bf16 v[80:95], a[108:111], a[100:103], v[80:95]
    v_mfma_f32_32x32x16_bf16 v[80:95], v[104:107], v[96:99], v[80:95]
    v_mfma_f32_32x32x16_bf16 v[80:95], v[108:111], v[100:103], v[80:95]
    s_nop 9
    v_mfma_f32_32x32x8_bf16 v[80:95], v[24:25], v[22:23], v[80:95]
    buffer_store_dwordx4 v[16:19], v4, s[16:19], s68 offen sc1
    s_nop 10
    v_mul_f32 v80, v80, v39
    v_mul_f32 v81, v81, v39
    v_mul_f32 v82, v82, v39
    v_mul_f32 v83, v83, v39
    v_mul_f32 v84, v84, v39
    v_mul_f32 v85, v85, v39
    v_mul_f32 v86, v86, v39
    v_mul_f32 v87, v87, v39
    v_mul_f32 v88, v88, v39
    v_mul_f32 v89, v89, v39
    v_mul_f32 v90, v90, v39
    v_mul_f32 v91, v91, v39
    v_mul_f32 v92, v92, v39
    v_mul_f32 v93, v93, v39
    v_mul_f32 v94, v94, v39
    v_mul_f32 v95, v95, v39
    v_cvt_pk_bf16_f32 v112, v80, v81
    v_cvt_pk_bf16_f32 v113, v82, v83
    v_cvt_pk_bf16_f32 v114, v84, v85
    v_cvt_pk_bf16_f32 v115, v86, v87
    v_cvt_pk_bf16_f32 v116, v88, v89
    v_cvt_pk_bf16_f32 v117, v90, v91
    v_cvt_pk_bf16_f32 v118, v92, v93
    v_cvt_pk_bf16_f32 v119, v94, v95
    ds_write_b128 v46, v[112:115]
    ds_write_b128 v46, v[116:119] offset:2048
L_p1_join:
    s_and_b32 s62, s50, 3
    s_lshr_b32 s63, s50, 2
    s_lshl_b32 s64, s49, 2
    s_add_u32 s64, s64, s62
    s_lshl_b32 s65, s64, 17
    s_lshl_b32 s60, s63, 11
    s_add_u32 s65, s65, s60
    s_add_u32 s65, s65, s52
    s_lshr_b32 s71, s48, 2
    s_lshl_b32 s71, s71, 14
    s_lshl_b32 s70, s50, 12
    s_cmp_lt_u32 s50, 4
    s_cbranch_scc1 L43
    v_and_b32 v32, 3, v1
    v_cmp_eq_u32 vcc, 1, v32
    v_mov_b32 v33, 0x3f803f80
    s_nop 0
    v_cndmask_b32 v36, 0, v33, vcc
    v_mov_b32 v37, v36
    v_mov_b32 v38, v36
    v_mov_b32 v39, v36
    s_lshl_b32 s60, s50, 10
    s_add_u32 s60, s60, 29696
    v_add_u32 v32, s60, v4
    ds_write_b128 v32, v[36:39]
    s_cmp_lg_u32 s50, 5
    s_cbranch_scc1 L44
    s_lshr_b32 s60, s48, 2
    s_lshl_b32 s60, s60, 3
    s_add_u32 s60, s60, s49
    s_lshl_b32 s60, s60, 7
    s_add_u32 s60, s60, 40960
    s_add_u32 s60, s60, s53
    s_mov_b64 exec, 15
    s_mov_b32 s61, 200000
L45:
    buffer_load_dword v16, v4, s[16:19], s60 offen sc1
    s_waitcnt vmcnt(0)
    v_cmp_ne_u32 vcc, 1, v16
    s_cbranch_vccz L46
    s_sub_u32 s61, s61, 1
    s_cmp_lg_u32 s61, 0
    s_cbranch_scc1 L45
L46:
    s_mov_b64 exec, -1
L44:
L43:
    s_waitcnt lgkmcnt(0)
    s_barrier
    s_add_u32 s73, s65, s71
    s_add_u32 s71, s71, 16384
    s_and_b32 s71, s71, 0x1ffff
    s_add_u32 m0, s70, 0
    buffer_load_dwordx4 v[96:99], v4, s[16:19], s73 offen sc1
    buffer_load_dwordx4 v4, s[16:19], s73 offen offset:1024 sc1 lds
    s_addk_i32 s73, 4096
    s_add_u32 m0, s70, 1024
    buffer_load_dwordx4 v[100:103], v4, s[16:19], s73 offen sc1
    buffer_load_dwordx4 v4, s[16:19], s73 offen offset:1024 sc1 lds
    v_lshrrev_b32 v32, 5, v1
    v_lshlrev_b32 v18, 8, v32
    v_and_b32 v32, 15, v1
    v_lshl_add_u32 v18, v32, 4, v18
    v_add_u32 v18, s70, v18
    v_add_u32 v18, 1024, v18
    v_add_u32 v33, 4, v32
    v_and_b32 v33, 8, v33
    v_lshlrev_b32 v33, 3, v33
    v_add_u32 v33, 33792, v33
    v_and_b32 v32, 11, v1
    v_cmp_eq_u32 vcc, 0, v32
    v_add_u32 v32, 16, v33
    s_nop 0
    v_cndmask_b32 v33, v33, v32, vcc
    v_and_b32 v32, 16, v1
    v_cmp_eq_u32 vcc, 0, v32
    s_nop 1
    v_cndmask_b32 v18, v33, v18, vcc
    v_mov_b32 v19, 0xdddddddd
    s_mov_b32 s94, 0xffff
    s_mov_b32 s95, 0xffff
    v_mov_b32 v64, 0
    v_mov_b32 v65, 0
    v_mov_b32 v66, 0
    v_mov_b32 v67, 0
    v_mov_b32 v68, 0
    v_mov_b32 v69, 0
    v_mov_b32 v70, 0
    v_mov_b32 v71, 0
    v_mov_b32 v72, 0
    v_mov_b32 v73, 0
    v_mov_b32 v74, 0
    v_mov_b32 v75, 0
    v_mov_b32 v76, 0
    v_mov_b32 v77, 0
    v_mov_b32 v78, 0
    v_mov_b32 v79, 0
    v_mov_b32 v80, 0
    v_mov_b32 v81, 0
    v_mov_b32 v82, 0
    v_mov_b32 v83, 0
    v_mov_b32 v84, 0
    v_mov_b32 v85, 0
    v_mov_b32 v86, 0
    v_mov_b32 v87, 0
    v_mov_b32 v88, 0
    v_mov_b32 v89, 0
    v_mov_b32 v90, 0
    v_mov_b32 v91, 0
    v_mov_b32 v92, 0
    v_mov_b32 v93, 0
    v_mov_b32 v94, 0
    v_mov_b32 v95, 0
    s_cmp_ge_u32 s48, 28
    s_cselect_b32 s26, 0, s26
    s_cmp_lg_u32 s51, 0
    s_cselect_b32 s14, 0, s14
    s_lshr_b32 s66, s50, 1
    s_mul_i32 s66, s66, 1835008
    s_lshl_b32 s60, s48, 7
    s_add_u32 s66, s66, s60
    s_and_b32 s61, s50, 1
    s_lshl_b32 s61, s61, 6
    s_add_u32 s66, s66, s61
    s_sub_u32 s66, s66, 57344
    s_lshl_b32 s69, s49, 2
    s_and_b32 s61, s48, 3
    s_add_u32 s69, s69, s61
    s_lshl_b32 s69, s69, 3
    s_add_u32 s69, s69, s50
    s_mul_i32 s69, s69, 28672
    s_lshr_b32 s61, s48, 2
    s_lshl_b32 s61, s61, 9
    s_add_u32 s69, s69, s61
    v_lshrrev_b32 v20, 2, v1
    v_lshlrev_b32 v20, 12, v20
    v_and_b32 v33, 3, v1
    v_lshl_add_u32 v20, v33, 7, v20
    v_cmp_gt_u32 vcc, 28, v1
    v_mov_b32 v33, 0x40000000
    s_nop 0
    v_cndmask_b32 v20, v33, v20, vcc
    s_lshl_b32 s68, s50, 13
    s_lshl_b32 s60, s49, 7
    s_add_u32 s68, s68, s60
    s_lshl_b32 s60, s62, 11
    s_add_u32 s60, s60, 155648
    v_add_u32 v33, s60, v4
    v_subrev_u32 v23, 32768, v13
    v_lshrrev_b32 v34, 2, v1
    v_and_b32 v35, 3, v1
    v_lshlrev_b32 v35, 4, v35
    v_mul_u32_u24 v21, 3584, v34
    v_add_u32 v21, v21, v35
    v_lshrrev_b32 v34, 3, v1
    v_lshlrev_b32 v34, 11, v34
    v_sub_u32 v22, v14, v34
    s_lshl_b32 s72, s49, 10
    s_add_u32 s72, s72, 0
    s_add_u32 s72, s72, s53
    s_lshr_b32 s61, s48, 2
    s_lshl_b32 s61, s61, 7
    s_add_u32 s72, s72, s61
    s_lshl_b32 s60, s63, 10
    v_add_u32 v33, s60, v33
    v_xor_b32 v32, 1024, v33
    ds_read_b128 v[24:27], v32
    ds_read_b128 v[28:31], v33
    s_lshl_b32 s88, s48, 1
    s_add_u32 s88, s88, s63
    s_lshl_b32 s88, s88, 5
    s_add_u32 s88, s88, s64
    s_lshl_b32 s88, s88, 10
    s_add_u32 s88, s88, 4194304
    s_add_u32 s88, s88, s52
    s_and_b32 s90, s50, 1
    s_lshl_b32 s90, s90, 15
    s_lshr_b32 s60, s50, 1
    s_lshl_b32 s60, s60, 13
    s_add_u32 s90, s90, s60
    s_lshl_b32 s60, s48, 16
    s_add_u32 s90, s90, s60
    s_add_u32 s90, s90, 4194304
    s_add_u32 s90, s90, s52
    s_add_u32 s91, s90, 4096
    s_mul_i32 s92, s50, 3072
    s_add_u32 s92, s92, 37888
    s_xor_b32 s93, s50, 4
    s_mul_i32 s93, s93, 3072
    s_add_u32 s93, s93, 37888
    v_lshrrev_b32 v132, 5, v1
    v_lshlrev_b32 v132, 2, v132
    v_bfe_u32 v133, v1, 2, 2
    v_add_u32 v132, v132, v133
    v_lshlrev_b32 v131, 7, v132
    v_lshrrev_b32 v133, 1, v133
    v_xor_b32 v133, 0, v133
    v_lshl_add_u32 v131, v133, 6, v131
    v_bfe_u32 v133, v1, 4, 1
    v_lshl_add_u32 v131, v133, 5, v131
    v_and_b32 v133, 3, v1
    v_lshl_add_u32 v131, v133, 3, v131
    s_lshr_b32 s60, s50, 1
    s_lshl_b32 s60, s60, 14
    s_add_u32 s60, s60, 98304
    v_add_u32 v131, s60, v131
    s_setprio 1
    s_waitcnt vmcnt(2) lgkmcnt(0)
    v_mfma_f32_32x32x16_bf16 v[32:47], v[96:99], v[24:27], 0
    ds_read_b128 v[112:115], v18 offset:0
    ds_read_b128 v[116:119], v18 offset:512
    s_addk_i32 s73, 4096
    s_add_u32 m0, s70, 2048
    buffer_load_dwordx4 v[104:107], v4, s[16:19], s73 offen sc1
    buffer_load_dwordx4 v4, s[16:19], s73 offen offset:1024 sc1 lds
    s_addk_i32 s73, 4096
    s_add_u32 m0, s70, 3072
    buffer_load_dwordx4 v[108:111], v4, s[16:19], s73 offen sc1
    buffer_load_dwordx4 v4, s[16:19], s73 offen offset:1024 sc1 lds
    s_lshr_b32 s60, s48, 2
    s_lshl_b32 s60, s60, 9
    s_add_u32 s60, s60, 33685504
    v_and_b32 v17, 0x1f0, v4
    buffer_load_dword v17, v17, s[16:19], s60 offen sc1
    s_lshr_b32 s60, s2, 3
    s_lshl_b32 s60, s60, 3
    s_add_u32 s60, s60, s50
    s_lshl_b32 s61, s60, 11
    s_add_u32 s61, s61, 384
    v_min_u32 v129, 1, v1
    v_lshlrev_b32 v129, 10, v129
    buffer_load_dword v129, v129, s[20:23], s61 offen
    s_mul_i32 s60, s60, 28672
    s_or_b32 s61, s48, 3
    s_lshl_b32 s61, s61, 7
    s_add_u32 s60, s60, s61
    v_min_u32 v130, 7, v1
    v_mul_u32_u24 v130, 3584, v130
    buffer_load_dword v130, v130, s[24:27], s60 offen
    s_nop 1
    s_cmp_lg_u32 s63, 0
    s_cbranch_scc1 L47
    s_setprio 2
L47:
    v_exp_f32 v32, v32
    v_exp_f32 v33, v33
    v_exp_f32 v34, v34
    v_exp_f32 v35, v35
    v_exp_f32 v36, v36
    v_mfma_f32_32x32x16_bf16 v[48:63], v[96:99], v[28:31], 0
    v_exp_f32 v37, v37
    v_exp_f32 v38, v38
    v_exp_f32 v39, v39
    v_exp_f32 v40, v40
    v_exp_f32 v41, v41
    v_exp_f32 v42, v42
    s_waitcnt vmcnt(7) lgkmcnt(0)
    ds_read_b128 v[120:123], v18 offset:1024
    ds_read_b128 v[124:127], v18 offset:1536
    v_smfmac_f32_32x32x32_bf16 v[80:95], v[112:115], v[32:39], v19
    v_exp_f32 v43, v43
    v_exp_f32 v44, v44
    v_exp_f32 v45, v45
    v_exp_f32 v46, v46
    v_exp_f32 v47, v47
    v_exp_f32 v48, v48
    v_exp_f32 v49, v49
    v_smfmac_f32_32x32x32_bf16 v[80:95], v[116:119], v[40:47], v19
    v_exp_f32 v50, v50
    v_exp_f32 v51, v51
    v_exp_f32 v52, v52
    v_mfma_f32_32x32x16_bf16 v[32:47], v[100:103], v[24:27], 0
    v_exp_f32 v53, v53
    v_exp_f32 v54, v54
    v_exp_f32 v55, v55
    v_exp_f32 v56, v56
    v_exp_f32 v57, v57
    v_exp_f32 v58, v58
    s_add_u32 s67, s83, 0
    s_and_b32 s67, s67, 7
    s_mul_i32 s67, s67, 229376
    s_add_u32 s67, s67, s66
    s_add_u32 m0, s55, 0
    s_add_u32 s67, s67, 57344
    buffer_load_dwordx4 v21, s[24:27], s67 offen lds
    v_smfmac_f32_32x32x32_bf16 v[64:79], v[112:115], v[48:55], v19
    v_exp_f32 v59, v59
    v_exp_f32 v60, v60
    v_exp_f32 v61, v61
    v_exp_f32 v62, v62
    v_exp_f32 v63, v63
    v_exp_f32 v32, v32
    v_exp_f32 v33, v33
    v_smfmac_f32_32x32x32_bf16 v[64:79], v[116:119], v[56:63], v19
    v_exp_f32 v34, v34
    v_exp_f32 v35, v35
    v_exp_f32 v36, v36
    v_mfma_f32_32x32x16_bf16 v[48:63], v[100:103], v[28:31], 0
    v_exp_f32 v37, v37
    v_exp_f32 v38, v38
    v_exp_f32 v39, v39
    v_exp_f32 v40, v40
    v_exp_f32 v41, v41
    v_exp_f32 v42, v42
    s_waitcnt vmcnt(6) lgkmcnt(0)
    s_mov_b64 exec, 1
    buffer_load_dword v128, v4, s[16:19], s72 offen sc1
    s_mov_b64 exec, -1
    ds_read_b128 v[112:115], v18 offset:2048
    ds_read_b128 v[116:119], v18 offset:2560
    v_smfmac_f32_32x32x32_bf16 v[80:95], v[120:123], v[32:39], v19
    v_exp_f32 v43, v43
    v_exp_f32 v44, v44
    v_exp_f32 v45, v45
    v_exp_f32 v46, v46
    v_exp_f32 v47, v47
    v_exp_f32 v48, v48
    v_exp_f32 v49, v49
    v_smfmac_f32_32x32x32_bf16 v[80:95], v[124:127], v[40:47], v19
    v_exp_f32 v50, v50
    v_exp_f32 v51, v51
    v_exp_f32 v52, v52
    v_mfma_f32_32x32x16_bf16 v[32:47], v[104:107], v[24:27], 0
    v_exp_f32 v53, v53
    v_exp_f32 v54, v54
    v_exp_f32 v55, v55
    v_exp_f32 v56, v56
    v_exp_f32 v57, v57
    v_exp_f32 v58, v58
    s_add_u32 m0, s55, 8192
    s_add_u32 s67, s67, 57344
    buffer_load_dwordx4 v21, s[24:27], s67 offen lds
    s_add_u32 m0, s55, 32768
    s_add_u32 s60, s68, 0
    buffer_load_dwordx4 v22, s[20:23], s60 offen lds
    v_smfmac_f32_32x32x32_bf16 v[64:79], v[120:123], v[48:55], v19
    v_exp_f32 v59, v59
    v_exp_f32 v60, v60
    v_exp_f32 v61, v61
    v_exp_f32 v62, v62
    v_exp_f32 v63, v63
    v_exp_f32 v32, v32
    v_exp_f32 v33, v33
    v_smfmac_f32_32x32x32_bf16 v[64:79], v[124:127], v[56:63], v19
    v_exp_f32 v34, v34
    v_exp_f32 v35, v35
    v_exp_f32 v36, v36
    v_mfma_f32_32x32x16_bf16 v[48:63], v[104:107], v[28:31], 0
    v_exp_f32 v37, v37
    v_exp_f32 v38, v38
    v_exp_f32 v39, v39
    v_exp_f32 v40, v40
    v_exp_f32 v41, v41
    v_exp_f32 v42, v42
    s_waitcnt vmcnt(2) lgkmcnt(0)
    s_mov_b64 exec, 1
    s_mov_b32 s61, 200000
L48:
    v_cmp_ne_u32 vcc, 32, v128
    s_cbranch_vccz L49
    buffer_load_dword v128, v4, s[16:19], s72 offen sc1
    s_waitcnt vmcnt(0)
    s_sub_u32 s61, s61, 1
    s_cmp_lg_u32 s61, 0
    s_cbranch_scc1 L48
L49:
    s_mov_b64 exec, -1
    s_add_u32 s73, s65, s71
    s_add_u32 s71, s71, 16384
    s_and_b32 s71, s71, 0x1ffff
    s_add_u32 m0, s70, 0
    buffer_load_dwordx4 v[96:99], v4, s[16:19], s73 offen sc1
    buffer_load_dwordx4 v4, s[16:19], s73 offen offset:1024 sc1 lds
    s_addk_i32 s73, 4096
    s_add_u32 m0, s70, 1024
    buffer_load_dwordx4 v[100:103], v4, s[16:19], s73 offen sc1
    buffer_load_dwordx4 v4, s[16:19], s73 offen offset:1024 sc1 lds
    s_addk_i32 s73, 4096
    s_add_u32 m0, s70, 2048
    buffer_load_dwordx4 v[104:107], v4, s[16:19], s73 offen sc1
    buffer_load_dwordx4 v4, s[16:19], s73 offen offset:1024 sc1 lds
    ds_read_b128 v[120:123], v18 offset:3072
    ds_read_b128 v[124:127], v18 offset:3584
    v_smfmac_f32_32x32x32_bf16 v[80:95], v[112:115], v[32:39], v19
    v_exp_f32 v43, v43
    v_exp_f32 v44, v44
    v_exp_f32 v45, v45
    v_exp_f32 v46, v46
    v_exp_f32 v47, v47
    v_exp_f32 v48, v48
    v_exp_f32 v49, v49
    v_smfmac_f32_32x32x32_bf16 v[80:95], v[116:119], v[40:47], v19
    v_exp_f32 v50, v50
    v_exp_f32 v51, v51
    v_exp_f32 v52, v52
    v_mfma_f32_32x32x16_bf16 v[32:47], v[108:111], v[24:27], 0
    v_exp_f32 v53, v53
    v_exp_f32 v54, v54
    v_exp_f32 v55, v55
    v_exp_f32 v56, v56
    v_exp_f32 v57, v57
    v_exp_f32 v58, v58
    s_add_u32 m0, s55, 16384
    s_add_u32 s67, s67, 57344
    buffer_load_dwordx4 v21, s[24:27], s67 offen lds
    v_smfmac_f32_32x32x32_bf16 v[64:79], v[112:115], v[48:55], v19
    v_exp_f32 v59, v59
    v_exp_f32 v60, v60
    v_exp_f32 v61, v61
    v_exp_f32 v62, v62
    v_exp_f32 v63, v63
    v_exp_f32 v32, v32
    v_exp_f32 v33, v33
    v_smfmac_f32_32x32x32_bf16 v[64:79], v[116:119], v[56:63], v19
    v_exp_f32 v34, v34
    v_exp_f32 v35, v35
    v_exp_f32 v36, v36
    v_mfma_f32_32x32x16_bf16 v[48:63], v[108:111], v[28:31], 0
    v_exp_f32 v37, v37
    v_exp_f32 v38, v38
    v_exp_f32 v39, v39
    v_exp_f32 v40, v40
    v_exp_f32 v41, v41
    v_exp_f32 v42, v42
    s_waitcnt vmcnt(5) lgkmcnt(0)
    s_addk_i32 s73, 4096
    s_add_u32 m0, s70, 3072
    buffer_load_dwordx4 v[108:111], v4, s[16:19], s73 offen sc1
    buffer_load_dwordx4 v4, s[16:19], s73 offen offset:1024 sc1 lds
    ds_read_b128 v[112:115], v18 offset:0
    ds_read_b128 v[116:119], v18 offset:512
    v_smfmac_f32_32x32x32_bf16 v[80:95], v[120:123], v[32:39], v19
    v_exp_f32 v43, v43
    v_exp_f32 v44, v44
    v_exp_f32 v45, v45
    v_exp_f32 v46, v46
    v_exp_f32 v47, v47
    v_exp_f32 v48, v48
    v_exp_f32 v49, v49
    v_smfmac_f32_32x32x32_bf16 v[80:95], v[124:127], v[40:47], v19
    v_exp_f32 v50, v50
    v_exp_f32 v51, v51
    v_exp_f32 v52, v52
    v_mfma_f32_32x32x16_bf16 v[32:47], v[96:99], v[24:27], 0
    v_exp_f32 v53, v53
    v_exp_f32 v54, v54
    v_exp_f32 v55, v55
    v_exp_f32 v56, v56
    v_exp_f32 v57, v57
    v_exp_f32 v58, v58
    s_add_u32 m0, s55, 24576
    s_add_u32 s67, s67, 57344
    buffer_load_dwordx4 v21, s[24:27], s67 offen lds
    ds_read_b64_tr_b16 a[0:1], v23 offset:0
    ds_read_b64_tr_b16 a[2:3], v23 offset:256
    v_smfmac_f32_32x32x32_bf16 v[64:79], v[120:123], v[48:55], v19
    v_exp_f32 v59, v59
    v_exp_f32 v60, v60
    v_exp_f32 v61, v61
    v_exp_f32 v62, v62
    v_exp_f32 v63, v63
    v_exp_f32 v32, v32
    v_exp_f32 v33, v33
    v_smfmac_f32_32x32x32_bf16 v[64:79], v[124:127], v[56:63], v19
    v_exp_f32 v34, v34
    v_exp_f32 v35, v35
    v_exp_f32 v36, v36
    v_mfma_f32_32x32x16_bf16 v[48:63], v[96:99], v[28:31], 0
    v_exp_f32 v37, v37
    v_exp_f32 v38, v38
    v_exp_f32 v39, v39
    v_exp_f32 v40, v40
    v_exp_f32 v41, v41
    v_exp_f32 v42, v42
    s_waitcnt vmcnt(6) lgkmcnt(0)
    s_add_u32 s73, s65, s71
    s_add_u32 s71, s71, 16384
    s_and_b32 s71, s71, 0x1ffff
    s_add_u32 m0, s70, 0
    buffer_load_dwordx4 v[96:99], v4, s[16:19], s73 offen sc1
    buffer_load_dwordx4 v4, s[16:19], s73 offen offset:1024 sc1 lds
    ds_read_b128 v[120:123], v18 offset:1024
    ds_read_b128 v[124:127], v18 offset:1536
    v_smfmac_f32_32x32x32_bf16 v[80:95], v[112:115], v[32:39], v19
    v_exp_f32 v43, v43
    v_exp_f32 v44, v44
    v_exp_f32 v45, v45
    v_exp_f32 v46, v46
    v_exp_f32 v47, v47
    v_exp_f32 v48, v48
    v_exp_f32 v49, v49
    v_smfmac_f32_32x32x32_bf16 v[80:95], v[116:119], v[40:47], v19
    v_exp_f32 v50, v50
    v_exp_f32 v51, v51
    v_exp_f32 v52, v52
    v_mfma_f32_32x32x16_bf16 v[32:47], v[100:103], v[24:27], 0
    v_exp_f32 v53, v53
    v_exp_f32 v54, v54
    v_exp_f32 v55, v55
    v_exp_f32 v56, v56
    v_exp_f32 v57, v57
    v_exp_f32 v58, v58
    s_add_u32 s67, s83, 1
    s_and_b32 s67, s67, 7
    s_mul_i32 s67, s67, 229376
    s_add_u32 s67, s67, s66
    s_add_u32 m0, s55, 0
    s_add_u32 s67, s67, 57344
    buffer_load_dwordx4 v21, s[24:27], s67 offen lds
    ds_read_b64_tr_b16 a[4:5], v23 offset:8192
    ds_read_b64_tr_b16 a[6:7], v23 offset:8448
    s_add_u32 m0, s55, 40960
    s_add_u32 s60, s68, 65536
    buffer_load_dwordx4 v22, s[20:23], s60 offen lds
    v_smfmac_f32_32x32x32_bf16 v[64:79], v[112:115], v[48:55], v19
    v_exp_f32 v59, v59
    v_exp_f32 v60, v60
    v_exp_f32 v61, v61
    v_exp_f32 v62, v62
    v_exp_f32 v63, v63
    v_exp_f32 v32, v32
    v_exp_f32 v33, v33
    v_smfmac_f32_32x32x32_bf16 v[64:79], v[116:119], v[56:63], v19
    v_exp_f32 v34, v34
    v_exp_f32 v35, v35
    v_exp_f32 v36, v36
    v_mfma_f32_32x32x16_bf16 v[48:63], v[100:103], v[28:31], 0
    v_exp_f32 v37, v37
    v_exp_f32 v38, v38
    v_exp_f32 v39, v39
    v_exp_f32 v40, v40
    v_exp_f32 v41, v41
    v_exp_f32 v42, v42
    s_waitcnt vmcnt(7) lgkmcnt(0)
    s_addk_i32 s73, 4096
    s_add_u32 m0, s70, 1024
    buffer_load_dwordx4 v[100:103], v4, s[16:19], s73 offen sc1
    buffer_load_dwordx4 v4, s[16:19], s73 offen offset:1024 sc1 lds
    ds_read_b128 v[112:115], v18 offset:2048
    ds_read_b128 v[116:119], v18 offset:2560
    v_smfmac_f32_32x32x32_bf16 v[80:95], v[120:123], v[32:39], v19
    v_exp_f32 v43, v43
    v_exp_f32 v44, v44
    v_exp_f32 v45, v45
    v_exp_f32 v46, v46
    v_exp_f32 v47, v47
    v_exp_f32 v48, v48
    v_exp_f32 v49, v49
    v_smfmac_f32_32x32x32_bf16 v[80:95], v[124:127], v[40:47], v19
    v_exp_f32 v50, v50
    v_exp_f32 v51, v51
    v_exp_f32 v52, v52
    v_mfma_f32_32x32x16_bf16 v[32:47], v[104:107], v[24:27], 0
    v_exp_f32 v53, v53
    v_exp_f32 v54, v54
    v_exp_f32 v55, v55
    v_exp_f32 v56, v56
    v_exp_f32 v57, v57
    v_exp_f32 v58, v58
    s_add_u32 m0, s55, 8192
    s_add_u32 s67, s67, 57344
    buffer_load_dwordx4 v21, s[24:27], s67 offen lds
    ds_read_b64_tr_b16 a[8:9], v23 offset:16384
    ds_read_b64_tr_b16 a[10:11], v23 offset:16640
    v_smfmac_f32_32x32x32_bf16 v[64:79], v[120:123], v[48:55], v19
    v_exp_f32 v59, v59
    v_exp_f32 v60, v60
    v_exp_f32 v61, v61
    v_exp_f32 v62, v62
    v_exp_f32 v63, v63
    s_cmp_lg_u32 s63, 0
    s_cbranch_scc1 L50
    s_setprio 0
L50:
    v_exp_f32 v32, v32
    v_exp_f32 v33, v33
    v_smfmac_f32_32x32x32_bf16 v[64:79], v[124:127], v[56:63], v19
    v_exp_f32 v34, v34
    v_exp_f32 v35, v35
    v_exp_f32 v36, v36
    v_mfma_f32_32x32x16_bf16 v[48:63], v[104:107], v[28:31], 0
    v_exp_f32 v37, v37
    v_exp_f32 v38, v38
    v_exp_f32 v39, v39
    v_exp_f32 v40, v40
    v_exp_f32 v41, v41
    v_exp_f32 v42, v42
    s_waitcnt vmcnt(7) lgkmcnt(0)
    s_addk_i32 s73, 4096
    s_add_u32 m0, s70, 2048
    buffer_load_dwordx4 v[104:107], v4, s[16:19], s73 offen sc1
    buffer_load_dwordx4 v4, s[16:19], s73 offen offset:1024 sc1 lds
    ds_read_b128 v[120:123], v18 offset:3072
    ds_read_b128 v[124:127], v18 offset:3584
    v_smfmac_f32_32x32x32_bf16 v[80:95], v[112:115], v[32:39], v19
    v_exp_f32 v43, v43
    v_exp_f32 v44, v44
    v_exp_f32 v45, v45
    v_exp_f32 v46, v46
    v_exp_f32 v47, v47
    v_exp_f32 v48, v48
    v_exp_f32 v49, v49
    v_smfmac_f32_32x32x32_bf16 v[80:95], v[116:119], v[40:47], v19
    v_exp_f32 v50, v50
    v_exp_f32 v51, v51
    v_exp_f32 v52, v52
    v_mfma_f32_32x32x16_bf16 v[32:47], v[108:111], v[24:27], 0
    v_exp_f32 v53, v53
    v_exp_f32 v54, v54
    v_exp_f32 v55, v55
    v_exp_f32 v56, v56
    v_exp_f32 v57, v57
    v_exp_f32 v58, v58
    s_add_u32 m0, s55, 16384
    s_add_u32 s67, s67, 57344
    buffer_load_dwordx4 v21, s[24:27], s67 offen lds
    ds_read_b64_tr_b16 a[12:13], v23 offset:24576
    ds_read_b64_tr_b16 a[14:15], v23 offset:24832
    v_smfmac_f32_32x32x32_bf16 v[64:79], v[112:115], v[48:55], v19
    v_exp_f32 v59, v59
    v_exp_f32 v60, v60
    v_exp_f32 v61, v61
    v_exp_f32 v62, v62
    v_exp_f32 v63, v63
    v_exp_f32 v32, v32
    v_exp_f32 v33, v33
    v_smfmac_f32_32x32x32_bf16 v[64:79], v[116:119], v[56:63], v19
    v_exp_f32 v34, v34
    v_exp_f32 v35, v35
    v_exp_f32 v36, v36
    v_mfma_f32_32x32x16_bf16 v[48:63], v[108:111], v[28:31], 0
    v_exp_f32 v37, v37
    v_exp_f32 v38, v38
    v_exp_f32 v39, v39
    v_exp_f32 v40, v40
    v_exp_f32 v41, v41
    v_exp_f32 v42, v42
    s_waitcnt vmcnt(7) lgkmcnt(0)
    s_addk_i32 s73, 4096
    s_add_u32 m0, s70, 3072
    buffer_load_dwordx4 v[108:111], v4, s[16:19], s73 offen sc1
    buffer_load_dwordx4 v4, s[16:19], s73 offen offset:1024 sc1 lds
    ds_read_b128 v[112:115], v18 offset:0
    ds_read_b128 v[116:119], v18 offset:512
    v_smfmac_f32_32x32x32_bf16 v[80:95], v[120:123], v[32:39], v19
    v_exp_f32 v43, v43
    v_exp_f32 v44, v44
    v_exp_f32 v45, v45
    v_exp_f32 v46, v46
    v_exp_f32 v47, v47
    v_exp_f32 v48, v48
    v_exp_f32 v49, v49
    v_smfmac_f32_32x32x32_bf16 v[80:95], v[124:127], v[40:47], v19
    v_exp_f32 v50, v50
    v_exp_f32 v51, v51
    v_exp_f32 v52, v52
    v_mfma_f32_32x32x16_bf16 v[32:47], v[96:99], v[24:27], 0
    v_exp_f32 v53, v53
    v_exp_f32 v54, v54
    v_exp_f32 v55, v55
    v_exp_f32 v56, v56
    v_exp_f32 v57, v57
    v_exp_f32 v58, v58
    s_add_u32 m0, s55, 24576
    s_add_u32 s67, s67, 57344
    buffer_load_dwordx4 v21, s[24:27], s67 offen lds
    ds_read_b64_tr_b16 a[16:17], v23 offset:0
    ds_read_b64_tr_b16 a[18:19], v23 offset:256
    s_add_u32 m0, s55, 49152
    s_add_u32 s60, s68, 131072
    buffer_load_dwordx4 v22, s[20:23], s60 offen lds
    v_smfmac_f32_32x32x32_bf16 v[64:79], v[120:123], v[48:55], v19
    v_exp_f32 v59, v59
    v_exp_f32 v60, v60
    v_exp_f32 v61, v61
    v_exp_f32 v62, v62
    v_exp_f32 v63, v63
    s_cmp_lg_u32 s63, 0
    s_cbranch_scc1 L51
    s_setprio 2
L51:
    v_exp_f32 v32, v32
    v_exp_f32 v33, v33
    v_smfmac_f32_32x32x32_bf16 v[64:79], v[124:127], v[56:63], v19
    v_exp_f32 v34, v34
    v_exp_f32 v35, v35
    v_exp_f32 v36, v36
    v_mfma_f32_32x32x16_bf16 v[48:63], v[96:99], v[28:31], 0
    v_exp_f32 v37, v37
    v_exp_f32 v38, v38
    v_exp_f32 v39, v39
    v_exp_f32 v40, v40
    v_exp_f32 v41, v41
    v_exp_f32 v42, v42
    s_waitcnt vmcnt(7) lgkmcnt(0)
    s_add_u32 s73, s65, s71
    s_add_u32 s71, s71, 16384
    s_and_b32 s71, s71, 0x1ffff
    s_add_u32 m0, s70, 0
    buffer_load_dwordx4 v[96:99], v4, s[16:19], s73 offen sc1
    buffer_load_dwordx4 v4, s[16:19], s73 offen offset:1024 sc1 lds
    ds_read_b128 v[120:123], v18 offset:1024
    ds_read_b128 v[124:127], v18 offset:1536
    v_smfmac_f32_32x32x32_bf16 v[80:95], v[112:115], v[32:39], v19
    v_exp_f32 v43, v43
    v_exp_f32 v44, v44
    v_exp_f32 v45, v45
    v_exp_f32 v46, v46
    v_exp_f32 v47, v47
    v_exp_f32 v48, v48
    v_exp_f32 v49, v49
    v_smfmac_f32_32x32x32_bf16 v[80:95], v[116:119], v[40:47], v19
    v_exp_f32 v50, v50
    v_exp_f32 v51, v51
    v_exp_f32 v52, v52
    v_mfma_f32_32x32x16_bf16 v[32:47], v[100:103], v[24:27], 0
    v_exp_f32 v53, v53
    v_exp_f32 v54, v54
    v_exp_f32 v55, v55
    v_exp_f32 v56, v56
    v_exp_f32 v57, v57
    v_exp_f32 v58, v58
    s_add_u32 s67, s83, 2
    s_and_b32 s67, s67, 7
    s_mul_i32 s67, s67, 229376
    s_add_u32 s67, s67, s66
    s_add_u32 m0, s55, 0
    s_add_u32 s67, s67, 57344
    buffer_load_dwordx4 v21, s[24:27], s67 offen lds
    ds_read_b64_tr_b16 a[20:21], v23 offset:8192
    ds_read_b64_tr_b16 a[22:23], v23 offset:8448
    v_readfirstlane_b32 s60, v17
    s_nop 1
    v_cmp_ne_u32 vcc, s60, v17
    s_nop 1
    s_cmp_eq_u64 vcc, 0
    s_cselect_b32 s56, 1, 0
    v_smfmac_f32_32x32x32_bf16 v[64:79], v[112:115], v[48:55], v19
    v_exp_f32 v59, v59
    v_exp_f32 v60, v60
    v_exp_f32 v61, v61
    v_exp_f32 v62, v62
    v_exp_f32 v63, v63
    v_exp_f32 v32, v32
    v_exp_f32 v33, v33
    v_smfmac_f32_32x32x32_bf16 v[64:79], v[116:119], v[56:63], v19
    v_exp_f32 v34, v34
    v_exp_f32 v35, v35
    v_exp_f32 v36, v36
    v_mfma_f32_32x32x16_bf16 v[48:63], v[100:103], v[28:31], 0
    v_exp_f32 v37, v37
    v_exp_f32 v38, v38
    v_exp_f32 v39, v39
    v_exp_f32 v40, v40
    v_exp_f32 v41, v41
    v_exp_f32 v42, v42
    s_waitcnt vmcnt(7) lgkmcnt(0)
    s_addk_i32 s73, 4096
    s_add_u32 m0, s70, 1024
    buffer_load_dwordx4 v[100:103], v4, s[16:19], s73 offen sc1
    buffer_load_dwordx4 v4, s[16:19], s73 offen offset:1024 sc1 lds
    ds_read_b128 v[112:115], v18 offset:2048
    ds_read_b128 v[116:119], v18 offset:2560
    v_smfmac_f32_32x32x32_bf16 v[80:95], v[120:123], v[32:39], v19
    v_exp_f32 v43, v43
    v_exp_f32 v44, v44
    v_exp_f32 v45, v45
    v_exp_f32 v46, v46
    v_exp_f32 v47, v47
    v_exp_f32 v48, v48
    v_exp_f32 v49, v49
    v_smfmac_f32_32x32x32_bf16 v[80:95], v[124:127], v[40:47], v19
    v_exp_f32 v50, v50
    v_exp_f32 v51, v51
    v_exp_f32 v52, v52
    v_mfma_f32_32x32x16_bf16 v[32:47], v[104:107], v[24:27], 0
    v_exp_f32 v53, v53
    v_exp_f32 v54, v54
    v_exp_f32 v55, v55
    v_exp_f32 v56, v56
    v_exp_f32 v57, v57
    v_exp_f32 v58, v58
    s_add_u32 m0, s55, 8192
    s_add_u32 s67, s67, 57344
    buffer_load_dwordx4 v21, s[24:27], s67 offen lds
    ds_read_b64_tr_b16 a[24:25], v23 offset:16384
    ds_read_b64_tr_b16 a[26:27], v23 offset:16640
    v_smfmac_f32_32x32x32_bf16 v[64:79], v[120:123], v[48:55], v19
    v_exp_f32 v59, v59
    v_exp_f32 v60, v60
    v_exp_f32 v61, v61
    v_exp_f32 v62, v62
    v_exp_f32 v63, v63
    v_exp_f32 v32, v32
    v_exp_f32 v33, v33
    v_smfmac_f32_32x32x32_bf16 v[64:79], v[124:127], v[56:63], v19
    v_exp_f32 v34, v34
    v_exp_f32 v35, v35
    v_exp_f32 v36, v36
    v_mfma_f32_32x32x16_bf16 v[48:63], v[104:107], v[28:31], 0
    v_exp_f32 v37, v37
    v_exp_f32 v38, v38
    v_exp_f32 v39, v39
    v_exp_f32 v40, v40
    v_exp_f32 v41, v41
    v_exp_f32 v42, v42
    s_waitcnt vmcnt(7) lgkmcnt(0)
    s_addk_i32 s73, 4096
    s_add_u32 m0, s70, 2048
    buffer_load_dwordx4 v[104:107], v4, s[16:19], s73 offen sc1
    buffer_load_dwordx4 v4, s[16:19], s73 offen offset:1024 sc1 lds
    ds_read_b128 v[120:123], v18 offset:3072
    ds_read_b128 v[124:127], v18 offset:3584
    v_smfmac_f32_32x32x32_bf16 v[80:95], v[112:115], v[32:39], v19
    v_exp_f32 v43, v43
    v_exp_f32 v44, v44
    v_exp_f32 v45, v45
    v_exp_f32 v46, v46
    v_exp_f32 v47, v47
    v_exp_f32 v48, v48
    v_exp_f32 v49, v49
    v_smfmac_f32_32x32x32_bf16 v[80:95], v[116:119], v[40:47], v19
    v_exp_f32 v50, v50
    v_exp_f32 v51, v51
    v_exp_f32 v52, v52
    v_mfma_f32_32x32x16_bf16 v[32:47], v[108:111], v[24:27], 0
    v_exp_f32 v53, v53
    v_exp_f32 v54, v54
    v_exp_f32 v55, v55
    v_exp_f32 v56, v56
    v_exp_f32 v57, v57
    v_exp_f32 v58, v58
    s_add_u32 m0, s55, 16384
    s_add_u32 s67, s67, 57344
    buffer_load_dwordx4 v21, s[24:27], s67 offen lds
    ds_read_b64_tr_b16 a[28:29], v23 offset:24576
    ds_read_b64_tr_b16 a[30:31], v23 offset:24832
    s_add_u32 m0, s55, 57344
    s_add_u32 s60, s68, 196608
    buffer_load_dwordx4 v22, s[20:23], s60 offen lds
    v_smfmac_f32_32x32x32_bf16 v[64:79], v[112:115], v[48:55], v19
    v_exp_f32 v59, v59
    v_exp_f32 v60, v60
    v_exp_f32 v61, v61
    v_exp_f32 v62, v62
    v_exp_f32 v63, v63
    v_exp_f32 v32, v32
    v_exp_f32 v33, v33
    v_smfmac_f32_32x32x32_bf16 v[64:79], v[116:119], v[56:63], v19
    v_exp_f32 v34, v34
    v_exp_f32 v35, v35
    v_exp_f32 v36, v36
    v_mfma_f32_32x32x16_bf16 v[48:63], v[108:111], v[28:31], 0
    v_exp_f32 v37, v37
    v_exp_f32 v38, v38
    v_exp_f32 v39, v39
    v_exp_f32 v40, v40
    v_exp_f32 v41, v41
    v_exp_f32 v42, v42
    s_waitcnt vmcnt(7) lgkmcnt(0)
    s_addk_i32 s73, 4096
    s_add_u32 m0, s70, 3072
    buffer_load_dwordx4 v[108:111], v4, s[16:19], s73 offen sc1
    buffer_load_dwordx4 v4, s[16:19], s73 offen offset:1024 sc1 lds
    ds_read_b128 v[112:115], v18 offset:0
    ds_read_b128 v[116:119], v18 offset:512
    v_smfmac_f32_32x32x32_bf16 v[80:95], v[120:123], v[32:39], v19
    v_exp_f32 v43, v43
    v_exp_f32 v44, v44
    v_exp_f32 v45, v45
    v_exp_f32 v46, v46
    v_exp_f32 v47, v47
    v_exp_f32 v48, v48
    v_exp_f32 v49, v49
    v_smfmac_f32_32x32x32_bf16 v[80:95], v[124:127], v[40:47], v19
    v_exp_f32 v50, v50
    v_exp_f32 v51, v51
    v_exp_f32 v52, v52
    v_mfma_f32_32x32x16_bf16 v[32:47], v[96:99], v[24:27], 0
    v_exp_f32 v53, v53
    v_exp_f32 v54, v54
    v_exp_f32 v55, v55
    v_exp_f32 v56, v56
    v_exp_f32 v57, v57
    v_exp_f32 v58, v58
    s_add_u32 m0, s55, 24576
    s_add_u32 s67, s67, 57344
    buffer_load_dwordx4 v21, s[24:27], s67 offen lds
    ds_read_b64_tr_b16 a[32:33], v23 offset:0
    ds_read_b64_tr_b16 a[34:35], v23 offset:256
    v_smfmac_f32_32x32x32_bf16 v[64:79], v[120:123], v[48:55], v19
    v_exp_f32 v59, v59
    v_exp_f32 v60, v60
    v_exp_f32 v61, v61
    v_exp_f32 v62, v62
    v_exp_f32 v63, v63
    v_exp_f32 v32, v32
    v_exp_f32 v33, v33
    v_smfmac_f32_32x32x32_bf16 v[64:79], v[124:127], v[56:63], v19
    v_exp_f32 v34, v34
    v_exp_f32 v35, v35
    v_exp_f32 v36, v36
    v_mfma_f32_32x32x16_bf16 v[48:63], v[96:99], v[28:31], 0
    v_exp_f32 v37, v37
    v_exp_f32 v38, v38
    v_exp_f32 v39, v39
    v_exp_f32 v40, v40
    v_exp_f32 v41, v41
    v_exp_f32 v42, v42
    s_waitcnt vmcnt(7) lgkmcnt(0)
    s_add_u32 s73, s65, s71
    s_add_u32 s71, s71, 16384
    s_and_b32 s71, s71, 0x1ffff
    s_add_u32 m0, s70, 0
    buffer_load_dwordx4 v[96:99], v4, s[16:19], s73 offen sc1
    buffer_load_dwordx4 v4, s[16:19], s73 offen offset:1024 sc1 lds
    ds_read_b128 v[120:123], v18 offset:1024
    ds_read_b128 v[124:127], v18 offset:1536
    v_smfmac_f32_32x32x32_bf16 v[80:95], v[112:115], v[32:39], v19
    v_exp_f32 v43, v43
    v_exp_f32 v44, v44
    v_exp_f32 v45, v45
    v_exp_f32 v46, v46
    v_exp_f32 v47, v47
    v_exp_f32 v48, v48
    v_exp_f32 v49, v49
    v_smfmac_f32_32x32x32_bf16 v[80:95], v[116:119], v[40:47], v19
    v_exp_f32 v50, v50
    v_exp_f32 v51, v51
    v_exp_f32 v52, v52
    v_mfma_f32_32x32x16_bf16 v[32:47], v[100:103], v[24:27], 0
    v_exp_f32 v53, v53
    v_exp_f32 v54, v54
    v_exp_f32 v55, v55
    v_exp_f32 v56, v56
    v_exp_f32 v57, v57
    v_exp_f32 v58, v58
    s_add_u32 s67, s83, 3
    s_and_b32 s67, s67, 7
    s_mul_i32 s67, s67, 229376
    s_add_u32 s67, s67, s66
    s_add_u32 m0, s55, 0
    s_add_u32 s67, s67, 57344
    buffer_load_dwordx4 v21, s[24:27], s67 offen lds
    ds_read_b64_tr_b16 a[36:37], v23 offset:8192
    ds_read_b64_tr_b16 a[38:39], v23 offset:8448
    v_smfmac_f32_32x32x32_bf16 v[64:79], v[112:115], v[48:55], v19
    v_exp_f32 v59, v59
    v_exp_f32 v60, v60
    v_exp_f32 v61, v61
    v_exp_f32 v62, v62
    v_exp_f32 v63, v63
    v_exp_f32 v32, v32
    v_exp_f32 v33, v33
    v_smfmac_f32_32x32x32_bf16 v[64:79], v[116:119], v[56:63], v19
    v_exp_f32 v34, v34
    v_exp_f32 v35, v35
    v_exp_f32 v36, v36
    v_mfma_f32_32x32x16_bf16 v[48:63], v[100:103], v[28:31], 0
    v_exp_f32 v37, v37
    v_exp_f32 v38, v38
    v_exp_f32 v39, v39
    v_exp_f32 v40, v40
    v_exp_f32 v41, v41
    v_exp_f32 v42, v42
    s_waitcnt vmcnt(7) lgkmcnt(0)
    s_addk_i32 s73, 4096
    s_add_u32 m0, s70, 1024
    buffer_load_dwordx4 v[100:103], v4, s[16:19], s73 offen sc1
    buffer_load_dwordx4 v4, s[16:19], s73 offen offset:1024 sc1 lds
    ds_read_b128 v[112:115], v18 offset:2048
    ds_read_b128 v[116:119], v18 offset:2560
    v_smfmac_f32_32x32x32_bf16 v[80:95], v[120:123], v[32:39], v19
    v_exp_f32 v43, v43
    v_exp_f32 v44, v44
    v_exp_f32 v45, v45
    v_exp_f32 v46, v46
    v_exp_f32 v47, v47
    v_exp_f32 v48, v48
    v_exp_f32 v49, v49
    v_smfmac_f32_32x32x32_bf16 v[80:95], v[124:127], v[40:47], v19
    v_exp_f32 v50, v50
    v_exp_f32 v51, v51
    v_exp_f32 v52, v52
    v_mfma_f32_32x32x16_bf16 v[32:47], v[104:107], v[24:27], 0
    v_exp_f32 v53, v53
    v_exp_f32 v54, v54
    v_exp_f32 v55, v55
    v_exp_f32 v56, v56
    v_exp_f32 v57, v57
    v_exp_f32 v58, v58
    s_add_u32 m0, s55, 8192
    s_add_u32 s67, s67, 57344
    buffer_load_dwordx4 v21, s[24:27], s67 offen lds
    ds_read_b64_tr_b16 a[40:41], v23 offset:16384
    ds_read_b64_tr_b16 a[42:43], v23 offset:16640
    s_add_u32 m0, s55, 65536
    s_add_u32 s60, s68, 262144
    buffer_load_dwordx4 v22, s[20:23], s60 offen lds
    v_smfmac_f32_32x32x32_bf16 v[64:79], v[120:123], v[48:55], v19
    v_exp_f32 v59, v59
    v_exp_f32 v60, v60
    v_exp_f32 v61, v61
    v_exp_f32 v62, v62
    v_exp_f32 v63, v63
    s_cmp_lg_u32 s63, 0
    s_cbranch_scc1 L52
    s_setprio 0
L52:
    v_exp_f32 v32, v32
    v_exp_f32 v33, v33
    v_smfmac_f32_32x32x32_bf16 v[64:79], v[124:127], v[56:63], v19
    v_exp_f32 v34, v34
    v_exp_f32 v35, v35
    v_exp_f32 v36, v36
    v_mfma_f32_32x32x16_bf16 v[48:63], v[104:107], v[28:31], 0
    v_exp_f32 v37, v37
    v_exp_f32 v38, v38
    v_exp_f32 v39, v39
    v_exp_f32 v40, v40
    v_exp_f32 v41, v41
    v_exp_f32 v42, v42
    s_waitcnt vmcnt(7) lgkmcnt(0)
    s_addk_i32 s73, 4096
    s_add_u32 m0, s70, 2048
    buffer_load_dwordx4 v[104:107], v4, s[16:19], s73 offen sc1
    buffer_load_dwordx4 v4, s[16:19], s73 offen offset:1024 sc1 lds
    ds_read_b128 v[120:123], v18 offset:3072
    ds_read_b128 v[124:127], v18 offset:3584
    v_smfmac_f32_32x32x32_bf16 v[80:95], v[112:115], v[32:39], v19
    v_exp_f32 v43, v43
    v_exp_f32 v44, v44
    v_exp_f32 v45, v45
    v_exp_f32 v46, v46
    v_exp_f32 v47, v47
    v_exp_f32 v48, v48
    v_exp_f32 v49, v49
    v_smfmac_f32_32x32x32_bf16 v[80:95], v[116:119], v[40:47], v19
    v_exp_f32 v50, v50
    v_exp_f32 v51, v51
    v_exp_f32 v52, v52
    v_mfma_f32_32x32x16_bf16 v[32:47], v[108:111], v[24:27], 0
    v_exp_f32 v53, v53
    v_exp_f32 v54, v54
    v_exp_f32 v55, v55
    v_exp_f32 v56, v56
    v_exp_f32 v57, v57
    v_exp_f32 v58, v58
    s_add_u32 m0, s55, 16384
    s_add_u32 s67, s67, 57344
    buffer_load_dwordx4 v21, s[24:27], s67 offen lds
    ds_read_b64_tr_b16 a[44:45], v23 offset:24576
    ds_read_b64_tr_b16 a[46:47], v23 offset:24832
    v_smfmac_f32_32x32x32_bf16 v[64:79], v[112:115], v[48:55], v19
    v_exp_f32 v59, v59
    v_exp_f32 v60, v60
    v_exp_f32 v61, v61
    v_exp_f32 v62, v62
    v_exp_f32 v63, v63
    v_exp_f32 v32, v32
    v_exp_f32 v33, v33
    v_smfmac_f32_32x32x32_bf16 v[64:79], v[116:119], v[56:63], v19
    v_exp_f32 v34, v34
    v_exp_f32 v35, v35
    v_exp_f32 v36, v36
    v_mfma_f32_32x32x16_bf16 v[48:63], v[108:111], v[28:31], 0
    v_exp_f32 v37, v37
    v_exp_f32 v38, v38
    v_exp_f32 v39, v39
    v_exp_f32 v40, v40
    v_exp_f32 v41, v41
    v_exp_f32 v42, v42
    s_waitcnt vmcnt(7) lgkmcnt(0)
    s_addk_i32 s73, 4096
    s_add_u32 m0, s70, 3072
    buffer_load_dwordx4 v[108:111], v4, s[16:19], s73 offen sc1
    buffer_load_dwordx4 v4, s[16:19], s73 offen offset:1024 sc1 lds
    ds_read_b128 v[112:115], v18 offset:0
    ds_read_b128 v[116:119], v18 offset:512
    v_smfmac_f32_32x32x32_bf16 v[80:95], v[120:123], v[32:39], v19
    v_exp_f32 v43, v43
    v_exp_f32 v44, v44
    v_exp_f32 v45, v45
    v_exp_f32 v46, v46
    v_exp_f32 v47, v47
    v_exp_f32 v48, v48
    v_exp_f32 v49, v49
    v_smfmac_f32_32x32x32_bf16 v[80:95], v[124:127], v[40:47], v19
    v_exp_f32 v50, v50
    v_exp_f32 v51, v51
    v_exp_f32 v52, v52
    v_mfma_f32_32x32x16_bf16 v[32:47], v[96:99], v[24:27], 0
    v_exp_f32 v53, v53
    v_exp_f32 v54, v54
    v_exp_f32 v55, v55
    v_exp_f32 v56, v56
    v_exp_f32 v57, v57
    v_exp_f32 v58, v58
    s_add_u32 m0, s55, 24576
    s_add_u32 s67, s67, 57344
    buffer_load_dwordx4 v21, s[24:27], s67 offen lds
    ds_read_b64_tr_b16 a[48:49], v23 offset:0
    ds_read_b64_tr_b16 a[50:51], v23 offset:256
    v_smfmac_f32_32x32x32_bf16 v[64:79], v[120:123], v[48:55], v19
    v_exp_f32 v59, v59
    v_exp_f32 v60, v60
    v_exp_f32 v61, v61
    v_exp_f32 v62, v62
    v_exp_f32 v63, v63
    s_cmp_lg_u32 s63, 0
    s_cbranch_scc1 L53
    s_setprio 2
L53:
    v_exp_f32 v32, v32
    v_exp_f32 v33, v33
    v_smfmac_f32_32x32x32_bf16 v[64:79], v[124:127], v[56:63], v19
    v_exp_f32 v34, v34
    v_exp_f32 v35, v35
    v_exp_f32 v36, v36
    v_mfma_f32_32x32x16_bf16 v[48:63], v[96:99], v[28:31], 0
    v_exp_f32 v37, v37
    v_exp_f32 v38, v38
    v_exp_f32 v39, v39
    v_exp_f32 v40, v40
    v_exp_f32 v41, v41
    v_exp_f32 v42, v42
    s_waitcnt vmcnt(7) lgkmcnt(0)
    s_add_u32 s73, s65, s71
    s_add_u32 s71, s71, 16384
    s_and_b32 s71, s71, 0x1ffff
    s_add_u32 m0, s70, 0
    buffer_load_dwordx4 v[96:99], v4, s[16:19], s73 offen sc1
    buffer_load_dwordx4 v4, s[16:19], s73 offen offset:1024 sc1 lds
    ds_read_b128 v[120:123], v18 offset:1024
    ds_read_b128 v[124:127], v18 offset:1536
    v_smfmac_f32_32x32x32_bf16 v[80:95], v[112:115], v[32:39], v19
    v_exp_f32 v43, v43
    v_exp_f32 v44, v44
    v_exp_f32 v45, v45
    v_exp_f32 v46, v46
    v_exp_f32 v47, v47
    v_exp_f32 v48, v48
    v_exp_f32 v49, v49
    v_smfmac_f32_32x32x32_bf16 v[80:95], v[116:119], v[40:47], v19
    v_exp_f32 v50, v50
    v_exp_f32 v51, v51
    v_exp_f32 v52, v52
    v_mfma_f32_32x32x16_bf16 v[32:47], v[100:103], v[24:27], 0
    v_exp_f32 v53, v53
    v_exp_f32 v54, v54
    v_exp_f32 v55, v55
    v_exp_f32 v56, v56
    v_exp_f32 v57, v57
    v_exp_f32 v58, v58
    s_add_u32 s67, s83, 4
    s_and_b32 s67, s67, 7
    s_mul_i32 s67, s67, 229376
    s_add_u32 s67, s67, s66
    s_add_u32 m0, s55, 0
    s_add_u32 s67, s67, 57344
    buffer_load_dwordx4 v21, s[24:27], s67 offen lds
    ds_read_b64_tr_b16 a[52:53], v23 offset:8192
    ds_read_b64_tr_b16 a[54:55], v23 offset:8448
    s_add_u32 m0, s55, 73728
    s_add_u32 s60, s68, 327680
    buffer_load_dwordx4 v22, s[20:23], s60 offen lds
    v_smfmac_f32_32x32x32_bf16 v[64:79], v[112:115], v[48:55], v19
    v_exp_f32 v59, v59
    v_exp_f32 v60, v60
    v_exp_f32 v61, v61
    v_exp_f32 v62, v62
    v_exp_f32 v63, v63
    v_exp_f32 v32, v32
    v_exp_f32 v33, v33
    v_smfmac_f32_32x32x32_bf16 v[64:79], v[116:119], v[56:63], v19
    v_exp_f32 v34, v34
    v_exp_f32 v35, v35
    v_exp_f32 v36, v36
    v_mfma_f32_32x32x16_bf16 v[48:63], v[100:103], v[28:31], 0
    v_exp_f32 v37, v37
    v_exp_f32 v38, v38
    v_exp_f32 v39, v39
    v_exp_f32 v40, v40
    v_exp_f32 v41, v41
    v_exp_f32 v42, v42
    s_waitcnt vmcnt(7) lgkmcnt(0)
    s_addk_i32 s73, 4096
    s_add_u32 m0, s70, 1024
    buffer_load_dwordx4 v[100:103], v4, s[16:19], s73 offen sc1
    buffer_load_dwordx4 v4, s[16:19], s73 offen offset:1024 sc1 lds
    ds_read_b128 v[112:115], v18 offset:2048
    ds_read_b128 v[116:119], v18 offset:2560
    v_smfmac_f32_32x32x32_bf16 v[80:95], v[120:123], v[32:39], v19
    v_exp_f32 v43, v43
    v_exp_f32 v44, v44
    v_exp_f32 v45, v45
    v_exp_f32 v46, v46
    v_exp_f32 v47, v47
    v_exp_f32 v48, v48
    v_exp_f32 v49, v49
    v_smfmac_f32_32x32x32_bf16 v[80:95], v[124:127], v[40:47], v19
    v_exp_f32 v50, v50
    v_exp_f32 v51, v51
    v_exp_f32 v52, v52
    v_mfma_f32_32x32x16_bf16 v[32:47], v[104:107], v[24:27], 0
    v_exp_f32 v53, v53
    v_exp_f32 v54, v54
    v_exp_f32 v55, v55
    v_exp_f32 v56, v56
    v_exp_f32 v57, v57
    v_exp_f32 v58, v58
    s_add_u32 m0, s55, 8192
    s_add_u32 s67, s67, 57344
    buffer_load_dwordx4 v21, s[24:27], s67 offen lds
    ds_read_b64_tr_b16 a[56:57], v23 offset:16384
    ds_read_b64_tr_b16 a[58:59], v23 offset:16640
    v_smfmac_f32_32x32x32_bf16 v[64:79], v[120:123], v[48:55], v19
    v_exp_f32 v59, v59
    v_exp_f32 v60, v60
    v_exp_f32 v61, v61
    v_exp_f32 v62, v62
    v_exp_f32 v63, v63
    v_exp_f32 v32, v32
    v_exp_f32 v33, v33
    v_smfmac_f32_32x32x32_bf16 v[64:79], v[124:127], v[56:63], v19
    v_exp_f32 v34, v34
    v_exp_f32 v35, v35
    v_exp_f32 v36, v36
    v_mfma_f32_32x32x16_bf16 v[48:63], v[104:107], v[28:31], 0
    v_exp_f32 v37, v37
    v_exp_f32 v38, v38
    v_exp_f32 v39, v39
    v_exp_f32 v40, v40
    v_exp_f32 v41, v41
    v_exp_f32 v42, v42
    s_waitcnt vmcnt(7) lgkmcnt(0)
    s_addk_i32 s73, 4096
    s_add_u32 m0, s70, 2048
    buffer_load_dwordx4 v[104:107], v4, s[16:19], s73 offen sc1
    buffer_load_dwordx4 v4, s[16:19], s73 offen offset:1024 sc1 lds
    ds_read_b128 v[120:123], v18 offset:3072
    ds_read_b128 v[124:127], v18 offset:3584
    v_smfmac_f32_32x32x32_bf16 v[80:95], v[112:115], v[32:39], v19
    v_exp_f32 v43, v43
    v_exp_f32 v44, v44
    v_exp_f32 v45, v45
    v_exp_f32 v46, v46
    v_exp_f32 v47, v47
    v_exp_f32 v48, v48
    v_exp_f32 v49, v49
    v_smfmac_f32_32x32x32_bf16 v[80:95], v[116:119], v[40:47], v19
    v_exp_f32 v50, v50
    v_exp_f32 v51, v51
    v_exp_f32 v52, v52
    v_mfma_f32_32x32x16_bf16 v[32:47], v[108:111], v[24:27], 0
    v_exp_f32 v53, v53
    v_exp_f32 v54, v54
    v_exp_f32 v55, v55
    v_exp_f32 v56, v56
    v_exp_f32 v57, v57
    v_exp_f32 v58, v58
    s_add_u32 m0, s55, 16384
    s_add_u32 s67, s67, 57344
    buffer_load_dwordx4 v21, s[24:27], s67 offen lds
    ds_read_b64_tr_b16 a[60:61], v23 offset:24576
    ds_read_b64_tr_b16 a[62:63], v23 offset:24832
    v_smfmac_f32_32x32x32_bf16 v[64:79], v[112:115], v[48:55], v19
    v_exp_f32 v59, v59
    v_exp_f32 v60, v60
    v_exp_f32 v61, v61
    v_exp_f32 v62, v62
    v_exp_f32 v63, v63
    v_exp_f32 v32, v32
    v_exp_f32 v33, v33
    v_smfmac_f32_32x32x32_bf16 v[64:79], v[116:119], v[56:63], v19
    v_exp_f32 v34, v34
    v_exp_f32 v35, v35
    v_exp_f32 v36, v36
    v_mfma_f32_32x32x16_bf16 v[48:63], v[108:111], v[28:31], 0
    v_exp_f32 v37, v37
    v_exp_f32 v38, v38
    v_exp_f32 v39, v39
    v_exp_f32 v40, v40
    v_exp_f32 v41, v41
    v_exp_f32 v42, v42
    s_waitcnt vmcnt(7) lgkmcnt(0)
    s_addk_i32 s73, 4096
    s_add_u32 m0, s70, 3072
    buffer_load_dwordx4 v[108:111], v4, s[16:19], s73 offen sc1
    buffer_load_dwordx4 v4, s[16:19], s73 offen offset:1024 sc1 lds
    ds_read_b128 v[112:115], v18 offset:0
    ds_read_b128 v[116:119], v18 offset:512
    v_smfmac_f32_32x32x32_bf16 v[80:95], v[120:123], v[32:39], v19
    v_exp_f32 v43, v43
    v_exp_f32 v44, v44
    v_exp_f32 v45, v45
    v_exp_f32 v46, v46
    v_exp_f32 v47, v47
    v_exp_f32 v48, v48
    v_exp_f32 v49, v49
    v_smfmac_f32_32x32x32_bf16 v[80:95], v[124:127], v[40:47], v19
    v_exp_f32 v50, v50
    v_exp_f32 v51, v51
    v_exp_f32 v52, v52
    v_mfma_f32_32x32x16_bf16 v[32:47], v[96:99], v[24:27], 0
    v_exp_f32 v53, v53
    v_exp_f32 v54, v54
    v_exp_f32 v55, v55
    v_exp_f32 v56, v56
    v_exp_f32 v57, v57
    v_exp_f32 v58, v58
    s_add_u32 m0, s55, 24576
    s_add_u32 s67, s67, 57344
    buffer_load_dwordx4 v21, s[24:27], s67 offen lds
    ds_read_b64_tr_b16 a[64:65], v23 offset:0
    ds_read_b64_tr_b16 a[66:67], v23 offset:256
    s_add_u32 m0, s55, 81920
    s_add_u32 s60, s68, 393216
    buffer_load_dwordx4 v22, s[20:23], s60 offen lds
    v_smfmac_f32_32x32x32_bf16 v[64:79], v[120:123], v[48:55], v19
    v_exp_f32 v59, v59
    v_exp_f32 v60, v60
    v_exp_f32 v61, v61
    v_exp_f32 v62, v62
    v_exp_f32 v63, v63
    v_exp_f32 v32, v32
    v_exp_f32 v33, v33
    v_smfmac_f32_32x32x32_bf16 v[64:79], v[124:127], v[56:63], v19
    v_exp_f32 v34, v34
    v_exp_f32 v35, v35
    v_exp_f32 v36, v36
    v_mfma_f32_32x32x16_bf16 v[48:63], v[96:99], v[28:31], 0
    v_exp_f32 v37, v37
    v_exp_f32 v38, v38
    v_exp_f32 v39, v39
    v_exp_f32 v40, v40
    v_exp_f32 v41, v41
    v_exp_f32 v42, v42
    s_waitcnt vmcnt(7) lgkmcnt(0)
    s_add_u32 s73, s65, s71
    s_add_u32 s71, s71, 16384
    s_and_b32 s71, s71, 0x1ffff
    s_add_u32 m0, s70, 0
    buffer_load_dwordx4 v[96:99], v4, s[16:19], s73 offen sc1
    buffer_load_dwordx4 v4, s[16:19], s73 offen offset:1024 sc1 lds
    ds_read_b128 v[120:123], v18 offset:1024
    ds_read_b128 v[124:127], v18 offset:1536
    v_smfmac_f32_32x32x32_bf16 v[80:95], v[112:115], v[32:39], v19
    v_exp_f32 v43, v43
    v_exp_f32 v44, v44
    v_exp_f32 v45, v45
    v_exp_f32 v46, v46
    v_exp_f32 v47, v47
    v_exp_f32 v48, v48
    v_exp_f32 v49, v49
    v_smfmac_f32_32x32x32_bf16 v[80:95], v[116:119], v[40:47], v19
    v_exp_f32 v50, v50
    v_exp_f32 v51, v51
    v_exp_f32 v52, v52
    v_mfma_f32_32x32x16_bf16 v[32:47], v[100:103], v[24:27], 0
    v_exp_f32 v53, v53
    v_exp_f32 v54, v54
    v_exp_f32 v55, v55
    v_exp_f32 v56, v56
    v_exp_f32 v57, v57
    v_exp_f32 v58, v58
    s_add_u32 s67, s83, 5
    s_and_b32 s67, s67, 7
    s_mul_i32 s67, s67, 229376
    s_add_u32 s67, s67, s66
    s_add_u32 m0, s55, 0
    s_add_u32 s67, s67, 57344
    buffer_load_dwordx4 v21, s[24:27], s67 offen lds
    ds_read_b64_tr_b16 a[68:69], v23 offset:8192
    ds_read_b64_tr_b16 a[70:71], v23 offset:8448
    v_smfmac_f32_32x32x32_bf16 v[64:79], v[112:115], v[48:55], v19
    v_exp_f32 v59, v59
    v_exp_f32 v60, v60
    v_exp_f32 v61, v61
    v_exp_f32 v62, v62
    v_exp_f32 v63, v63
    v_exp_f32 v32, v32
    v_exp_f32 v33, v33
    v_smfmac_f32_32x32x32_bf16 v[64:79], v[116:119], v[56:63], v19
    v_exp_f32 v34, v34
    v_exp_f32 v35, v35
    v_exp_f32 v36, v36
    v_mfma_f32_32x32x16_bf16 v[48:63], v[100:103], v[28:31], 0
    v_exp_f32 v37, v37
    v_exp_f32 v38, v38
    v_exp_f32 v39, v39
    v_exp_f32 v40, v40
    v_exp_f32 v41, v41
    v_exp_f32 v42, v42
    s_waitcnt vmcnt(7) lgkmcnt(0)
    s_addk_i32 s73, 4096
    s_add_u32 m0, s70, 1024
    buffer_load_dwordx4 v[100:103], v4, s[16:19], s73 offen sc1
    buffer_load_dwordx4 v4, s[16:19], s73 offen offset:1024 sc1 lds
    ds_read_b128 v[112:115], v18 offset:2048
    ds_read_b128 v[116:119], v18 offset:2560
    v_smfmac_f32_32x32x32_bf16 v[80:95], v[120:123], v[32:39], v19
    v_exp_f32 v43, v43
    v_exp_f32 v44, v44
    v_exp_f32 v45, v45
    v_exp_f32 v46, v46
    v_exp_f32 v47, v47
    v_exp_f32 v48, v48
    v_exp_f32 v49, v49
    v_smfmac_f32_32x32x32_bf16 v[80:95], v[124:127], v[40:47], v19
    v_exp_f32 v50, v50
    v_exp_f32 v51, v51
    v_exp_f32 v52, v52
    v_mfma_f32_32x32x16_bf16 v[32:47], v[104:107], v[24:27], 0
    v_exp_f32 v53, v53
    v_exp_f32 v54, v54
    v_exp_f32 v55, v55
    v_exp_f32 v56, v56
    v_exp_f32 v57, v57
    v_exp_f32 v58, v58
    s_add_u32 m0, s55, 8192
    s_add_u32 s67, s67, 57344
    buffer_load_dwordx4 v21, s[24:27], s67 offen lds
    ds_read_b64_tr_b16 a[72:73], v23 offset:16384
    ds_read_b64_tr_b16 a[74:75], v23 offset:16640
    v_smfmac_f32_32x32x32_bf16 v[64:79], v[120:123], v[48:55], v19
    v_exp_f32 v59, v59
    v_exp_f32 v60, v60
    v_exp_f32 v61, v61
    v_exp_f32 v62, v62
    v_exp_f32 v63, v63
    s_cmp_lg_u32 s63, 0
    s_cbranch_scc1 L54
    s_setprio 0
L54:
    v_exp_f32 v32, v32
    v_exp_f32 v33, v33
    v_smfmac_f32_32x32x32_bf16 v[64:79], v[124:127], v[56:63], v19
    v_exp_f32 v34, v34
    v_exp_f32 v35, v35
    v_exp_f32 v36, v36
    v_mfma_f32_32x32x16_bf16 v[48:63], v[104:107], v[28:31], 0
    v_exp_f32 v37, v37
    v_exp_f32 v38, v38
    v_exp_f32 v39, v39
    v_exp_f32 v40, v40
    v_exp_f32 v41, v41
    v_exp_f32 v42, v42
    s_waitcnt vmcnt(7) lgkmcnt(0)
    s_addk_i32 s73, 4096
    s_add_u32 m0, s70, 2048
    buffer_load_dwordx4 v[104:107], v4, s[16:19], s73 offen sc1
    buffer_load_dwordx4 v4, s[16:19], s73 offen offset:1024 sc1 lds
    ds_read_b128 v[120:123], v18 offset:3072
    ds_read_b128 v[124:127], v18 offset:3584
    v_smfmac_f32_32x32x32_bf16 v[80:95], v[112:115], v[32:39], v19
    v_exp_f32 v43, v43
    v_exp_f32 v44, v44
    v_exp_f32 v45, v45
    v_exp_f32 v46, v46
    v_exp_f32 v47, v47
    v_exp_f32 v48, v48
    v_exp_f32 v49, v49
    v_smfmac_f32_32x32x32_bf16 v[80:95], v[116:119], v[40:47], v19
    v_exp_f32 v50, v50
    v_exp_f32 v51, v51
    v_exp_f32 v52, v52
    v_mfma_f32_32x32x16_bf16 v[32:47], v[108:111], v[24:27], 0
    v_exp_f32 v53, v53
    v_exp_f32 v54, v54
    v_exp_f32 v55, v55
    v_exp_f32 v56, v56
    v_exp_f32 v57, v57
    v_exp_f32 v58, v58
    s_add_u32 m0, s55, 16384
    s_add_u32 s67, s67, 57344
    buffer_load_dwordx4 v21, s[24:27], s67 offen lds
    ds_read_b64_tr_b16 a[76:77], v23 offset:24576
    ds_read_b64_tr_b16 a[78:79], v23 offset:24832
    s_add_u32 m0, s55, 90112
    s_add_u32 s60, s68, 458752
    buffer_load_dwordx4 v22, s[20:23], s60 offen lds
    v_smfmac_f32_32x32x32_bf16 v[64:79], v[112:115], v[48:55], v19
    v_exp_f32 v59, v59
    v_exp_f32 v60, v60
    v_exp_f32 v61, v61
    v_exp_f32 v62, v62
    v_exp_f32 v63, v63
    v_exp_f32 v32, v32
    v_exp_f32 v33, v33
    v_smfmac_f32_32x32x32_bf16 v[64:79], v[116:119], v[56:63], v19
    v_exp_f32 v34, v34
    v_exp_f32 v35, v35
    v_exp_f32 v36, v36
    v_mfma_f32_32x32x16_bf16 v[48:63], v[108:111], v[28:31], 0
    v_exp_f32 v37, v37
    v_exp_f32 v38, v38
    v_exp_f32 v39, v39
    v_exp_f32 v40, v40
    v_exp_f32 v41, v41
    v_exp_f32 v42, v42
    s_waitcnt vmcnt(7) lgkmcnt(0)
    s_addk_i32 s73, 4096
    s_add_u32 m0, s70, 3072
    buffer_load_dwordx4 v[108:111], v4, s[16:19], s73 offen sc1
    buffer_load_dwordx4 v4, s[16:19], s73 offen offset:1024 sc1 lds
    ds_read_b128 v[112:115], v18 offset:0
    ds_read_b128 v[116:119], v18 offset:512
    v_smfmac_f32_32x32x32_bf16 v[80:95], v[120:123], v[32:39], v19
    v_exp_f32 v43, v43
    v_exp_f32 v44, v44
    v_exp_f32 v45, v45
    v_exp_f32 v46, v46
    v_exp_f32 v47, v47
    v_exp_f32 v48, v48
    v_exp_f32 v49, v49
    v_smfmac_f32_32x32x32_bf16 v[80:95], v[124:127], v[40:47], v19
    v_exp_f32 v50, v50
    v_exp_f32 v51, v51
    v_exp_f32 v52, v52
    v_mfma_f32_32x32x16_bf16 v[32:47], v[96:99], v[24:27], 0
    v_exp_f32 v53, v53
    v_exp_f32 v54, v54
    v_exp_f32 v55, v55
    v_exp_f32 v56, v56
    v_exp_f32 v57, v57
    v_exp_f32 v58, v58
    s_add_u32 m0, s55, 24576
    s_add_u32 s67, s67, 57344
    buffer_load_dwordx4 v21, s[24:27], s67 offen lds
    ds_read_b64_tr_b16 a[80:81], v23 offset:0
    ds_read_b64_tr_b16 a[82:83], v23 offset:256
    v_smfmac_f32_32x32x32_bf16 v[64:79], v[120:123], v[48:55], v19
    v_exp_f32 v59, v59
    v_exp_f32 v60, v60
    v_exp_f32 v61, v61
    v_exp_f32 v62, v62
    v_exp_f32 v63, v63
    s_cmp_lg_u32 s63, 0
    s_cbranch_scc1 L55
    s_setprio 2
L55:
    v_exp_f32 v32, v32
    v_exp_f32 v33, v33
    v_smfmac_f32_32x32x32_bf16 v[64:79], v[124:127], v[56:63], v19
    v_exp_f32 v34, v34
    v_exp_f32 v35, v35
    v_exp_f32 v36, v36
    v_mfma_f32_32x32x16_bf16 v[48:63], v[96:99], v[28:31], 0
    v_exp_f32 v37, v37
    v_exp_f32 v38, v38
    v_exp_f32 v39, v39
    v_exp_f32 v40, v40
    v_exp_f32 v41, v41
    v_exp_f32 v42, v42
    s_waitcnt vmcnt(7) lgkmcnt(0)
    s_add_u32 s73, s65, s71
    s_add_u32 s71, s71, 16384
    s_and_b32 s71, s71, 0x1ffff
    s_add_u32 m0, s70, 0
    buffer_load_dwordx4 v[96:99], v4, s[16:19], s73 offen sc1
    buffer_load_dwordx4 v4, s[16:19], s73 offen offset:1024 sc1 lds
    ds_read_b128 v[120:123], v18 offset:1024
    ds_read_b128 v[124:127], v18 offset:1536
    v_smfmac_f32_32x32x32_bf16 v[80:95], v[112:115], v[32:39], v19
    v_exp_f32 v43, v43
    v_exp_f32 v44, v44
    v_exp_f32 v45, v45
    v_exp_f32 v46, v46
    v_exp_f32 v47, v47
    v_exp_f32 v48, v48
    v_exp_f32 v49, v49
    v_smfmac_f32_32x32x32_bf16 v[80:95], v[116:119], v[40:47], v19
    v_exp_f32 v50, v50
    v_exp_f32 v51, v51
    v_exp_f32 v52, v52
    v_mfma_f32_32x32x16_bf16 v[32:47], v[100:103], v[24:27], 0
    v_exp_f32 v53, v53
    v_exp_f32 v54, v54
    v_exp_f32 v55, v55
    v_exp_f32 v56, v56
    v_exp_f32 v57, v57
    v_exp_f32 v58, v58
    s_add_u32 s67, s83, 6
    s_and_b32 s67, s67, 7
    s_mul_i32 s67, s67, 229376
    s_add_u32 s67, s67, s66
    s_add_u32 m0, s55, 0
    s_add_u32 s67, s67, 57344
    buffer_load_dwordx4 v21, s[24:27], s67 offen lds
    ds_read_b64_tr_b16 a[84:85], v23 offset:8192
    ds_read_b64_tr_b16 a[86:87], v23 offset:8448
    buffer_load_dword v16, v4, s[16:19], s88 offen sc1
    s_lshl_b32 s60, s48, 3
    s_add_u32 s60, s60, s49
    s_lshl_b32 s60, s60, 10
    s_add_u32 s60, s60, 12582912
    s_add_u32 s60, s60, s52
    buffer_load_dword v16, v4, s[16:19], s60 offen sc1
    v_smfmac_f32_32x32x32_bf16 v[64:79], v[112:115], v[48:55], v19
    v_exp_f32 v59, v59
    v_exp_f32 v60, v60
    v_exp_f32 v61, v61
    v_exp_f32 v62, v62
    v_exp_f32 v63, v63
    v_exp_f32 v32, v32
    v_exp_f32 v33, v33
    v_smfmac_f32_32x32x32_bf16 v[64:79], v[116:119], v[56:63], v19
    v_exp_f32 v34, v34
    v_exp_f32 v35, v35
    v_exp_f32 v36, v36
    v_mfma_f32_32x32x16_bf16 v[48:63], v[100:103], v[28:31], 0
    v_exp_f32 v37, v37
    v_exp_f32 v38, v38
    v_exp_f32 v39, v39
    v_exp_f32 v40, v40
    v_exp_f32 v41, v41
    v_exp_f32 v42, v42
    s_waitcnt vmcnt(9) lgkmcnt(0)
    s_addk_i32 s73, 4096
    s_add_u32 m0, s70, 1024
    buffer_load_dwordx4 v[100:103], v4, s[16:19], s73 offen sc1
    buffer_load_dwordx4 v4, s[16:19], s73 offen offset:1024 sc1 lds
    ds_read_b128 v[112:115], v18 offset:2048
    ds_read_b128 v[116:119], v18 offset:2560
    v_smfmac_f32_32x32x32_bf16 v[80:95], v[120:123], v[32:39], v19
    v_exp_f32 v43, v43
    v_exp_f32 v44, v44
    v_exp_f32 v45, v45
    v_exp_f32 v46, v46
    v_exp_f32 v47, v47
    v_exp_f32 v48, v48
    v_exp_f32 v49, v49
    v_smfmac_f32_32x32x32_bf16 v[80:95], v[124:127], v[40:47], v19
    v_exp_f32 v50, v50
    v_exp_f32 v51, v51
    v_exp_f32 v52, v52
    v_mfma_f32_32x32x16_bf16 v[32:47], v[104:107], v[24:27], 0
    v_exp_f32 v53, v53
    v_exp_f32 v54, v54
    v_exp_f32 v55, v55
    v_exp_f32 v56, v56
    v_exp_f32 v57, v57
    v_exp_f32 v58, v58
    s_add_u32 m0, s55, 8192
    s_add_u32 s67, s67, 57344
    buffer_load_dwordx4 v21, s[24:27], s67 offen lds
    ds_read_b64_tr_b16 a[88:89], v23 offset:16384
    ds_read_b64_tr_b16 a[90:91], v23 offset:16640
    v_smfmac_f32_32x32x32_bf16 v[64:79], v[120:123], v[48:55], v19
    v_exp_f32 v59, v59
    v_exp_f32 v60, v60
    v_exp_f32 v61, v61
    v_exp_f32 v62, v62
    v_exp_f32 v63, v63
    v_exp_f32 v32, v32
    v_exp_f32 v33, v33
    v_smfmac_f32_32x32x32_bf16 v[64:79], v[124:127], v[56:63], v19
    v_exp_f32 v34, v34
    v_exp_f32 v35, v35
    v_exp_f32 v36, v36
    v_mfma_f32_32x32x16_bf16 v[48:63], v[104:107], v[28:31], 0
    v_exp_f32 v37, v37
    v_exp_f32 v38, v38
    v_exp_f32 v39, v39
    v_exp_f32 v40, v40
    v_exp_f32 v41, v41
    v_exp_f32 v42, v42
    s_waitcnt vmcnt(8) lgkmcnt(0)
    s_addk_i32 s73, 4096
    s_add_u32 m0, s70, 2048
    buffer_load_dwordx4 v[104:107], v4, s[16:19], s73 offen sc1
    buffer_load_dwordx4 v4, s[16:19], s73 offen offset:1024 sc1 lds
    ds_read_b128 v[120:123], v18 offset:3072
    ds_read_b128 v[124:127], v18 offset:3584
    v_smfmac_f32_32x32x32_bf16 v[80:95], v[112:115], v[32:39], v19
    v_exp_f32 v43, v43
    v_exp_f32 v44, v44
    v_exp_f32 v45, v45
    v_exp_f32 v46, v46
    v_exp_f32 v47, v47
    v_exp_f32 v48, v48
    v_exp_f32 v49, v49
    v_smfmac_f32_32x32x32_bf16 v[80:95], v[116:119], v[40:47], v19
    v_exp_f32 v50, v50
    v_exp_f32 v51, v51
    v_exp_f32 v52, v52
    v_mfma_f32_32x32x16_bf16 v[32:47], v[108:111], v[24:27], 0
    v_exp_f32 v53, v53
    v_exp_f32 v54, v54
    v_exp_f32 v55, v55
    v_exp_f32 v56, v56
    v_exp_f32 v57, v57
    v_exp_f32 v58, v58
    s_add_u32 m0, s55, 16384
    s_add_u32 s67, s67, 57344
    buffer_load_dwordx4 v21, s[24:27], s67 offen lds
    ds_read_b64_tr_b16 a[92:93], v23 offset:24576
    ds_read_b64_tr_b16 a[94:95], v23 offset:24832
    v_smfmac_f32_32x32x32_bf16 v[64:79], v[112:115], v[48:55], v19
    v_exp_f32 v59, v59
    v_exp_f32 v60, v60
    v_exp_f32 v61, v61
    v_exp_f32 v62, v62
    v_exp_f32 v63, v63
    v_exp_f32 v32, v32
    v_exp_f32 v33, v33
    v_smfmac_f32_32x32x32_bf16 v[64:79], v[116:119], v[56:63], v19
    v_exp_f32 v34, v34
    v_exp_f32 v35, v35
    v_exp_f32 v36, v36
    v_mfma_f32_32x32x16_bf16 v[48:63], v[108:111], v[28:31], 0
    v_exp_f32 v37, v37
    v_exp_f32 v38, v38
    v_exp_f32 v39, v39
    v_exp_f32 v40, v40
    v_exp_f32 v41, v41
    v_exp_f32 v42, v42
    s_waitcnt vmcnt(8) lgkmcnt(0)
    s_addk_i32 s73, 4096
    s_add_u32 m0, s70, 3072
    buffer_load_dwordx4 v[108:111], v4, s[16:19], s73 offen sc1
    buffer_load_dwordx4 v4, s[16:19], s73 offen offset:1024 sc1 lds
    ds_read_b128 v[112:115], v18 offset:0
    ds_read_b128 v[116:119], v18 offset:512
    v_smfmac_f32_32x32x32_bf16 v[80:95], v[120:123], v[32:39], v19
    v_exp_f32 v43, v43
    v_exp_f32 v44, v44
    v_exp_f32 v45, v45
    v_exp_f32 v46, v46
    v_exp_f32 v47, v47
    v_exp_f32 v48, v48
    v_exp_f32 v49, v49
    v_smfmac_f32_32x32x32_bf16 v[80:95], v[124:127], v[40:47], v19
    v_exp_f32 v50, v50
    v_exp_f32 v51, v51
    v_exp_f32 v52, v52
    v_mfma_f32_32x32x16_bf16 v[32:47], v[96:99], v[24:27], 0
    v_exp_f32 v53, v53
    v_exp_f32 v54, v54
    v_exp_f32 v55, v55
    v_exp_f32 v56, v56
    v_exp_f32 v57, v57
    v_exp_f32 v58, v58
    s_add_u32 m0, s55, 24576
    s_add_u32 s67, s67, 57344
    buffer_load_dwordx4 v21, s[24:27], s67 offen lds
    ds_read_b64_tr_b16 a[96:97], v23 offset:0
    ds_read_b64_tr_b16 a[98:99], v23 offset:256
    v_smfmac_f32_32x32x32_bf16 v[64:79], v[120:123], v[48:55], v19
    v_exp_f32 v59, v59
    v_exp_f32 v60, v60
    v_exp_f32 v61, v61
    v_exp_f32 v62, v62
    v_exp_f32 v63, v63
    v_exp_f32 v32, v32
    v_exp_f32 v33, v33
    v_smfmac_f32_32x32x32_bf16 v[64:79], v[124:127], v[56:63], v19
    v_exp_f32 v34, v34
    v_exp_f32 v35, v35
    v_exp_f32 v36, v36
    v_mfma_f32_32x32x16_bf16 v[48:63], v[96:99], v[28:31], 0
    v_exp_f32 v37, v37
    v_exp_f32 v38, v38
    v_exp_f32 v39, v39
    v_exp_f32 v40, v40
    v_exp_f32 v41, v41
    v_exp_f32 v42, v42
    s_waitcnt vmcnt(6) lgkmcnt(0)
    ds_read_b128 v[120:123], v18 offset:1024
    ds_read_b128 v[124:127], v18 offset:1536
    v_smfmac_f32_32x32x32_bf16 v[80:95], v[112:115], v[32:39], v19
    v_exp_f32 v43, v43
    v_exp_f32 v44, v44
    v_exp_f32 v45, v45
    v_exp_f32 v46, v46
    v_exp_f32 v47, v47
    v_exp_f32 v48, v48
    v_exp_f32 v49, v49
    v_smfmac_f32_32x32x32_bf16 v[80:95], v[116:119], v[40:47], v19
    v_exp_f32 v50, v50
    v_exp_f32 v51, v51
    v_exp_f32 v52, v52
    v_mfma_f32_32x32x16_bf16 v[32:47], v[100:103], v[24:27], 0
    v_exp_f32 v53, v53
    v_exp_f32 v54, v54
    v_exp_f32 v55, v55
    v_exp_f32 v56, v56
    v_exp_f32 v57, v57
    v_exp_f32 v58, v58
    s_add_u32 s67, s83, 7
    s_and_b32 s67, s67, 7
    s_mul_i32 s67, s67, 229376
    s_add_u32 s67, s67, s66
    s_add_u32 m0, s55, 0
    s_add_u32 s67, s67, 57344
    buffer_load_dwordx4 v21, s[24:27], s67 offen lds
    ds_read_b64_tr_b16 a[100:101], v23 offset:8192
    ds_read_b64_tr_b16 a[102:103], v23 offset:8448
    buffer_load_dword v16, v20, s[28:31], s69 offen
    v_smfmac_f32_32x32x32_bf16 v[64:79], v[112:115], v[48:55], v19
    v_exp_f32 v59, v59
    v_exp_f32 v60, v60
    v_exp_f32 v61, v61
    v_exp_f32 v62, v62
    v_exp_f32 v63, v63
    v_exp_f32 v32, v32
    v_exp_f32 v33, v33
    v_smfmac_f32_32x32x32_bf16 v[64:79], v[116:119], v[56:63], v19
    v_exp_f32 v34, v34
    v_exp_f32 v35, v35
    v_exp_f32 v36, v36
    v_mfma_f32_32x32x16_bf16 v[48:63], v[100:103], v[28:31], 0
    v_exp_f32 v37, v37
    v_exp_f32 v38, v38
    v_exp_f32 v39, v39
    v_exp_f32 v40, v40
    v_exp_f32 v41, v41
    v_exp_f32 v42, v42
    s_waitcnt vmcnt(5) lgkmcnt(0)
    ds_read_b128 v[112:115], v18 offset:2048
    ds_read_b128 v[116:119], v18 offset:2560
    v_smfmac_f32_32x32x32_bf16 v[80:95], v[120:123], v[32:39], v19
    v_exp_f32 v43, v43
    v_exp_f32 v44, v44
    v_exp_f32 v45, v45
    v_exp_f32 v46, v46
    v_exp_f32 v47, v47
    v_exp_f32 v48, v48
    v_exp_f32 v49, v49
    v_smfmac_f32_32x32x32_bf16 v[80:95], v[124:127], v[40:47], v19
    v_exp_f32 v50, v50
    v_exp_f32 v51, v51
    v_exp_f32 v52, v52
    v_mfma_f32_32x32x16_bf16 v[32:47], v[104:107], v[24:27], 0
    v_exp_f32 v53, v53
    v_exp_f32 v54, v54
    v_exp_f32 v55, v55
    v_exp_f32 v56, v56
    v_exp_f32 v57, v57
    v_exp_f32 v58, v58
    s_add_u32 m0, s55, 8192
    s_add_u32 s67, s67, 57344
    buffer_load_dwordx4 v21, s[24:27], s67 offen lds
    ds_read_b64_tr_b16 a[104:105], v23 offset:16384
    ds_read_b64_tr_b16 a[106:107], v23 offset:16640
    v_smfmac_f32_32x32x32_bf16 v[64:79], v[120:123], v[48:55], v19
    v_exp_f32 v59, v59
    v_exp_f32 v60, v60
    v_exp_f32 v61, v61
    v_exp_f32 v62, v62
    v_exp_f32 v63, v63
    s_cmp_lg_u32 s63, 0
    s_cbranch_scc1 L56
    s_setprio 0
L56:
    v_exp_f32 v32, v32
    v_exp_f32 v33, v33
    v_smfmac_f32_32x32x32_bf16 v[64:79], v[124:127], v[56:63], v19
    v_exp_f32 v34, v34
    v_exp_f32 v35, v35
    v_exp_f32 v36, v36
    v_mfma_f32_32x32x16_bf16 v[48:63], v[104:107], v[28:31], 0
    v_exp_f32 v37, v37
    v_exp_f32 v38, v38
    v_exp_f32 v39, v39
    v_exp_f32 v40, v40
    v_exp_f32 v41, v41
    v_exp_f32 v42, v42
    s_waitcnt vmcnt(3) lgkmcnt(0)
    ds_read_b128 v[120:123], v18 offset:3072
    ds_read_b128 v[124:127], v18 offset:3584
    v_smfmac_f32_32x32x32_bf16 v[80:95], v[112:115], v[32:39], v19
    v_exp_f32 v43, v43
    v_exp_f32 v44, v44
    v_exp_f32 v45, v45
    v_exp_f32 v46, v46
    v_exp_f32 v47, v47
    v_exp_f32 v48, v48
    v_exp_f32 v49, v49
    v_smfmac_f32_32x32x32_bf16 v[80:95], v[116:119], v[40:47], v19
    v_exp_f32 v50, v50
    v_exp_f32 v51, v51
    v_exp_f32 v52, v52
    v_mfma_f32_32x32x16_bf16 v[32:47], v[108:111], v[24:27], 0
    v_exp_f32 v53, v53
    v_exp_f32 v54, v54
    v_exp_f32 v55, v55
    v_exp_f32 v56, v56
    v_exp_f32 v57, v57
    v_exp_f32 v58, v58
    s_add_u32 m0, s55, 16384
    s_add_u32 s67, s67, 57344
    buffer_load_dwordx4 v21, s[24:27], s67 offen lds
    ds_read_b64_tr_b16 a[108:109], v23 offset:24576
    ds_read_b64_tr_b16 a[110:111], v23 offset:24832
    v_smfmac_f32_32x32x32_bf16 v[64:79], v[112:115], v[48:55], v19
    v_exp_f32 v59, v59
    v_exp_f32 v60, v60
    v_exp_f32 v61, v61
    v_exp_f32 v62, v62
    v_exp_f32 v63, v63
    v_exp_f32 v32, v32
    v_exp_f32 v33, v33
    v_smfmac_f32_32x32x32_bf16 v[64:79], v[116:119], v[56:63], v19
    v_exp_f32 v34, v34
    v_exp_f32 v35, v35
    v_exp_f32 v36, v36
    v_mfma_f32_32x32x16_bf16 v[48:63], v[108:111], v[28:31], 0
    v_exp_f32 v37, v37
    v_exp_f32 v38, v38
    v_exp_f32 v39, v39
    v_exp_f32 v40, v40
    v_exp_f32 v41, v41
    v_exp_f32 v42, v42
    s_waitcnt vmcnt(63) lgkmcnt(0)
    v_smfmac_f32_32x32x32_bf16 v[80:95], v[120:123], v[32:39], v19
    v_exp_f32 v43, v43
    v_exp_f32 v44, v44
    v_exp_f32 v45, v45
    v_exp_f32 v46, v46
    v_exp_f32 v47, v47
    v_exp_f32 v48, v48
    v_exp_f32 v49, v49
    v_smfmac_f32_32x32x32_bf16 v[80:95], v[124:127], v[40:47], v19
    v_exp_f32 v50, v50
    v_exp_f32 v51, v51
    v_exp_f32 v52, v52
    v_exp_f32 v53, v53
    v_exp_f32 v54, v54
    v_exp_f32 v55, v55
    v_exp_f32 v56, v56
    v_exp_f32 v57, v57
    v_exp_f32 v58, v58
    s_add_u32 m0, s55, 24576
    s_add_u32 s67, s67, 57344
    buffer_load_dwordx4 v21, s[24:27], s67 offen lds
    v_smfmac_f32_32x32x32_bf16 v[64:79], v[120:123], v[48:55], v19
    s_mov_b32 m0, s92
    v_mov_b32 v20, v131
    v_xor_b32 v22, 64, v131
    ds_write_addtid_b32 v80 offset:0
    ds_write_addtid_b32 v81 offset:256
    ds_write_addtid_b32 v82 offset:512
    ds_write_addtid_b32 v83 offset:768
    ds_write_addtid_b32 v84 offset:1024
    ds_write_addtid_b32 v85 offset:1280
    ds_write_addtid_b32 v86 offset:1536
    ds_write_addtid_b32 v87 offset:1792
    ds_write_addtid_b32 v88 offset:2048
    v_exp_f32 v59, v59
    v_exp_f32 v60, v60
    v_exp_f32 v61, v61
    v_exp_f32 v62, v62
    v_exp_f32 v63, v63
    s_nop 1
    v_smfmac_f32_32x32x32_bf16 v[64:79], v[124:127], v[56:63], v19
    s_setprio 0
    s_mov_b32 m0, s93
    s_waitcnt lgkmcnt(0)
    s_barrier
    ds_read_addtid_b32 v36 offset:0
    ds_read_addtid_b32 v37 offset:256
    ds_read_addtid_b32 v38 offset:512
    ds_read_addtid_b32 v39 offset:768
    ds_read_addtid_b32 v40 offset:1024
    ds_read_addtid_b32 v41 offset:1280
    ds_read_addtid_b32 v42 offset:1536
    ds_read_addtid_b32 v43 offset:1792
    ds_read_addtid_b32 v44 offset:2048
    ds_read_b64_tr_b16 v[80:81], v20 offset:0
    ds_read_b64_tr_b16 v[82:83], v20 offset:1024
    ds_read_b64_tr_b16 v[84:85], v22 offset:0
    ds_read_b64_tr_b16 v[86:87], v22 offset:1024
    ds_read_b64_tr_b16 v[88:89], v20 offset:2048
    ds_read_b64_tr_b16 v[90:91], v20 offset:3072
    s_waitcnt lgkmcnt(6)
    v_add_f32 v64, v64, v36
    v_add_f32 v65, v65, v37
    v_add_f32 v66, v66, v38
    v_add_f32 v67, v67, v39
    v_add_f32 v68, v68, v40
    v_add_f32 v69, v69, v41
    v_add_f32 v70, v70, v42
    v_add_f32 v71, v71, v43
    v_add_f32 v72, v72, v44
    ds_read_b64_tr_b16 v[92:93], v22 offset:2048
    ds_read_b64_tr_b16 v[94:95], v22 offset:3072
    v_add_f32 v36, abs(v64), abs(v65)
    v_add_f32 v37, abs(v66), abs(v67)
    v_add_f32 v38, abs(v68), abs(v69)
    v_add_f32 v39, abs(v70), abs(v71)
    v_add_f32 v36, v36, v37
    v_add_f32 v38, v38, v39
    v_cmp_nge_f32 vcc, 0x5d800000, v72
    v_add_f32 v36, v36, v38
    s_mov_b64 s[72:73], vcc
    v_cmp_nle_f32 vcc, 0x21800000, v72
    s_nop 0
    s_or_b64 s[72:73], s[72:73], vcc
    v_cmp_ngt_f32 vcc, 0x7f800000, v36
    s_nop 0
    s_or_b64 s[72:73], s[72:73], vcc
    s_cbranch_scc1 L_softmax_safe
L_softmax_done:
    v_rcp_f32 v72, v72
    s_nop 0
    v_mul_f32 v64, v64, v72
    v_mul_f32 v65, v65, v72
    v_mul_f32 v66, v66, v72
    v_mul_f32 v67, v67, v72
    v_mul_f32 v68, v68, v72
    v_mul_f32 v69, v69, v72
    v_mul_f32 v70, v70, v72
    v_mul_f32 v71, v71, v72
    v_cvt_pk_bf16_f32 v36, v64, v65
    v_cvt_pk_bf16_f32 v37, v66, v67
    v_cvt_pk_bf16_f32 v38, v68, v69
    v_cvt_pk_bf16_f32 v39, v70, v71
    v_min_u32 v36, -2, v36
    v_min_u32 v37, -2, v37
    v_min_u32 v38, -2, v38
    v_min_u32 v39, -2, v39
    s_cmp_eq_u32 s56, 1
    s_cbranch_scc1 L57
    buffer_store_dwordx4 v[36:39], v4, s[16:19], s88 offen sc1
    s_branch L58
L57:
    buffer_store_dwordx4 v[36:39], v4, s[16:19], s88 offen
L58:
    ds_read_b64_tr_b16 v[96:97], v20 offset:4096
    ds_read_b64_tr_b16 v[98:99], v20 offset:5120
    ds_read_b64_tr_b16 v[100:101], v22 offset:4096
    ds_read_b64_tr_b16 v[102:103], v22 offset:5120
    ds_read_b64_tr_b16 v[104:105], v20 offset:6144
    ds_read_b64_tr_b16 v[106:107], v20 offset:7168
    ds_read_b64_tr_b16 v[108:109], v22 offset:6144
    ds_read_b64_tr_b16 v[110:111], v22 offset:7168
    ds_read_b64_tr_b16 v[112:113], v20 offset:8192
    ds_read_b64_tr_b16 v[114:115], v20 offset:9216
    ds_read_b64_tr_b16 v[116:117], v22 offset:8192
    ds_read_b64_tr_b16 v[118:119], v22 offset:9216
    ds_read_b64_tr_b16 v[120:121], v20 offset:10240
    ds_read_b64_tr_b16 v[122:123], v20 offset:11264
    ds_read_b64_tr_b16 v[124:125], v22 offset:10240
    ds_read_b64_tr_b16 v[126:127], v22 offset:11264
    ds_read_b64_tr_b16 v[128:129], v20 offset:12288
    ds_read_b64_tr_b16 v[130:131], v20 offset:13312
    ds_read_b64_tr_b16 v[132:133], v22 offset:12288
    ds_read_b64_tr_b16 v[134:135], v22 offset:13312
    ds_read_b64_tr_b16 v[136:137], v20 offset:14336
    ds_read_b64_tr_b16 v[138:139], v20 offset:15360
    ds_read_b64_tr_b16 v[140:141], v22 offset:14336
    ds_read_b64_tr_b16 v[142:143], v22 offset:15360
    s_mov_b32 s66, 200000
    s_waitcnt vmcnt(0) lgkmcnt(0)
    s_barrier
L59:
    buffer_load_dwordx4 v[16:19], v4, s[16:19], s90 offen offset:0 sc1
    buffer_load_dwordx4 v[20:23], v4, s[16:19], s90 offen offset:1024 sc1
    buffer_load_dwordx4 v[24:27], v4, s[16:19], s90 offen offset:2048 sc1
    buffer_load_dwordx4 v[28:31], v4, s[16:19], s90 offen offset:3072 sc1
    buffer_load_dwordx4 v[32:35], v4, s[16:19], s91 offen offset:0 sc1
    buffer_load_dwordx4 v[36:39], v4, s[16:19], s91 offen offset:1024 sc1
    buffer_load_dwordx4 v[40:43], v4, s[16:19], s91 offen offset:2048 sc1
    buffer_load_dwordx4 v[44:47], v4, s[16:19], s91 offen offset:3072 sc1
    s_waitcnt vmcnt(7)
    v_mfma_f32_32x32x16_bf16 v[48:63], v[16:19], v[80:83], 0
    v_max_u32 v0, v16, v17
    v_mfma_f32_32x32x16_bf16 v[64:79], v[16:19], v[84:87], 0
    v_max3_u32 v0, v0, v18, v19
    s_waitcnt vmcnt(6)
    v_mfma_f32_32x32x16_bf16 v[48:63], v[20:23], v[88:91], v[48:63]
    v_max3_u32 v0, v0, v20, v21
    v_mfma_f32_32x32x16_bf16 v[64:79], v[20:23], v[92:95], v[64:79]
    v_max3_u32 v0, v0, v22, v23
    s_waitcnt vmcnt(5)
    v_mfma_f32_32x32x16_bf16 v[48:63], v[24:27], v[96:99], v[48:63]
    v_max3_u32 v0, v0, v24, v25
    v_mfma_f32_32x32x16_bf16 v[64:79], v[24:27], v[100:103], v[64:79]
    v_max3_u32 v0, v0, v26, v27
    s_waitcnt vmcnt(4)
    v_mfma_f32_32x32x16_bf16 v[48:63], v[28:31], v[104:107], v[48:63]
    v_max3_u32 v0, v0, v28, v29
    v_mfma_f32_32x32x16_bf16 v[64:79], v[28:31], v[108:111], v[64:79]
    v_max3_u32 v0, v0, v30, v31
    s_waitcnt vmcnt(3)
    v_mfma_f32_32x32x16_bf16 v[48:63], v[32:35], v[112:115], v[48:63]
    v_max3_u32 v0, v0, v32, v33
    v_mfma_f32_32x32x16_bf16 v[64:79], v[32:35], v[116:119], v[64:79]
    v_max3_u32 v0, v0, v34, v35
    s_waitcnt vmcnt(2)
    v_mfma_f32_32x32x16_bf16 v[48:63], v[36:39], v[120:123], v[48:63]
    v_max3_u32 v0, v0, v36, v37
    v_mfma_f32_32x32x16_bf16 v[64:79], v[36:39], v[124:127], v[64:79]
    v_max3_u32 v0, v0, v38, v39
    s_waitcnt vmcnt(1)
    v_mfma_f32_32x32x16_bf16 v[48:63], v[40:43], v[128:131], v[48:63]
    v_max3_u32 v0, v0, v40, v41
    v_mfma_f32_32x32x16_bf16 v[64:79], v[40:43], v[132:135], v[64:79]
    v_max3_u32 v0, v0, v42, v43
    s_waitcnt vmcnt(0)
    v_mfma_f32_32x32x16_bf16 v[48:63], v[44:47], v[136:139], v[48:63]
    v_max3_u32 v0, v0, v44, v45
    v_mfma_f32_32x32x16_bf16 v[64:79], v[44:47], v[140:143], v[64:79]
    v_max3_u32 v0, v0, v46, v47
    v_cmp_eq_u32 vcc, -1, v0
    s_sub_u32 s66, s66, 1
    s_cselect_b64 vcc, 0, vcc
    s_cbranch_vccnz L59
    s_and_b32 s60, s50, 1
    s_lshl_b32 s60, s60, 2
    s_lshr_b32 s61, s50, 1
    s_add_u32 s60, s60, s61
    s_lshl_b32 s64, s60, 12
    s_lshr_b32 s60, s50, 2
    s_lshl_b32 s60, s60, 14
    s_and_b32 s61, s50, 3
    s_lshl_b32 s61, s61, 10
    s_add_u32 s60, s60, s61
    s_add_u32 s60, s60, 98304
    v_and_b32 v80, 3, v2
    v_lshlrev_b32 v88, 8, v80
    v_bfe_u32 v80, v2, 2, 1
    v_lshl_add_u32 v88, v80, 7, v88
    v_and_b32 v80, 3, v3
    v_lshl_add_u32 v88, v80, 5, v88
    v_add_u32 v88, s60, v88
    v_lshrrev_b32 v80, 2, v3
    v_mul_i32_i24 v80, -98288, v80
    v_add_u32 v88, v88, v80
    s_add_u32 m0, s64, 36612
    s_nop 0
    ds_write_addtid_b32 v48 offset:61692
    ds_write_addtid_b32 v49 offset:61948
    ds_write_addtid_b32 v50 offset:62204
    ds_write_addtid_b32 v51 offset:62460
    ds_write_addtid_b32 v52 offset:62716
    ds_write_addtid_b32 v53 offset:62972
    ds_write_addtid_b32 v54 offset:63228
    ds_write_addtid_b32 v55 offset:63484
    ds_write_addtid_b32 v56 offset:63740
    ds_write_addtid_b32 v57 offset:63996
    ds_write_addtid_b32 v58 offset:64252
    ds_write_addtid_b32 v59 offset:64508
    ds_write_addtid_b32 v60 offset:64764
    ds_write_addtid_b32 v61 offset:65020
    ds_write_addtid_b32 v62 offset:65276
    ds_write_addtid_b32 v63 offset:65532
    s_add_u32 m0, s64, 16
    s_nop 0
    ds_write_addtid_b32 v64 offset:0
    ds_write_addtid_b32 v65 offset:256
    ds_write_addtid_b32 v66 offset:512
    ds_write_addtid_b32 v67 offset:768
    ds_write_addtid_b32 v68 offset:1024
    ds_write_addtid_b32 v69 offset:1280
    ds_write_addtid_b32 v70 offset:1536
    ds_write_addtid_b32 v71 offset:1792
    ds_write_addtid_b32 v72 offset:2048
    ds_write_addtid_b32 v73 offset:2304
    ds_write_addtid_b32 v74 offset:2560
    ds_write_addtid_b32 v75 offset:2816
    ds_write_addtid_b32 v76 offset:3072
    ds_write_addtid_b32 v77 offset:3328
    ds_write_addtid_b32 v78 offset:3584
    ds_write_addtid_b32 v79 offset:3840
    v_lshlrev_b32 v96, 16, v8
    v_and_b32 v97, 0xffff0000, v8
    v_lshlrev_b32 v98, 16, v9
    v_and_b32 v99, 0xffff0000, v9
    v_lshlrev_b32 v100, 16, v10
    v_and_b32 v101, 0xffff0000, v10
    v_lshlrev_b32 v102, 16, v11
    v_and_b32 v103, 0xffff0000, v11
    s_add_u32 m0, s55, 65536
    s_add_u32 s60, s54, 0
    buffer_load_dwordx4 v12, s[28:31], s60 offen lds
    s_add_u32 m0, s55, 73728
    s_add_u32 s60, s54, 65536
    buffer_load_dwordx4 v12, s[28:31], s60 offen lds
    s_add_u32 m0, s55, 81920
    s_add_u32 s60, s54, 131072
    buffer_load_dwordx4 v12, s[28:31], s60 offen lds
    s_add_u32 m0, s55, 90112
    s_add_u32 s60, s54, 196608
    buffer_load_dwordx4 v12, s[28:31], s60 offen lds
    s_lshl_b32 s68, s48, 13
    s_add_u32 s68, s68, 12582912
    s_add_u32 s68, s68, s52
    s_lshl_b32 s67, s49, 10
    s_add_u32 s67, s67, s68
    s_lshl_b32 s69, s49, 18
    s_lshl_b32 s60, s48, 12
    s_add_u32 s69, s69, s60
    s_add_u32 s69, s69, 6291456
    s_add_u32 s69, s69, s52
    v_lshlrev_b32 v16, 4, v2
    v_lshl_add_u32 v17, v3, 10, v16
    v_lshrrev_b32 v18, 2, v3
    v_lshlrev_b32 v18, 17, v18
    v_lshl_add_u32 v18, v2, 6, v18
    v_and_b32 v19, 3, v3
    v_lshl_add_u32 v18, v19, 4, v18
    v_subrev_u32 v19, 32768, v13
    v_mov_b32 v20, 0
    v_mov_b32 v21, 1
    v_mov_b32 v22, 0
    v_mov_b32 v23, 1
    v_mov_b32 v24, 0x3f803f80
    s_mov_b32 s62, 0x01010101
    s_mov_b32 s63, 0x01010101
    s_mov_b32 s66, 200000
    s_waitcnt lgkmcnt(0)
    s_barrier
    ds_read_b128 v[104:107], v88 offset:0
    ds_read_b128 v[108:111], v88 offset:16
    ds_read_b128 v[112:115], v88 offset:4096
    ds_read_b128 v[116:119], v88 offset:4112
    ds_read_b128 v[120:123], v88 offset:8192
    ds_read_b128 v[124:127], v88 offset:8208
    ds_read_b128 v[128:131], v88 offset:12288
    ds_read_b128 v[132:135], v88 offset:12304
    s_waitcnt lgkmcnt(6)
    v_pk_add_f32 v[104:105], v[104:105], v[96:97]
    v_pk_add_f32 v[106:107], v[106:107], v[98:99]
    v_pk_add_f32 v[108:109], v[108:109], v[100:101]
    v_pk_add_f32 v[110:111], v[110:111], v[102:103]
    s_waitcnt lgkmcnt(4)
    v_pk_add_f32 v[104:105], v[104:105], v[112:113]
    v_pk_add_f32 v[106:107], v[106:107], v[114:115]
    v_pk_add_f32 v[108:109], v[108:109], v[116:117]
    v_pk_add_f32 v[110:111], v[110:111], v[118:119]
    s_waitcnt lgkmcnt(2)
    v_pk_add_f32 v[104:105], v[104:105], v[120:121]
    v_pk_add_f32 v[106:107], v[106:107], v[122:123]
    v_pk_add_f32 v[108:109], v[108:109], v[124:125]
    v_pk_add_f32 v[110:111], v[110:111], v[126:127]
    s_waitcnt lgkmcnt(0)
    v_pk_add_f32 v[104:105], v[104:105], v[128:129]
    v_pk_add_f32 v[106:107], v[106:107], v[130:131]
    v_pk_add_f32 v[108:109], v[108:109], v[132:133]
    v_pk_add_f32 v[110:111], v[110:111], v[134:135]
    v_cvt_pk_bf16_f32 v8, v104, v105
    v_cvt_pk_bf16_f32 v9, v106, v107
    v_cvt_pk_bf16_f32 v10, v108, v109
    v_cvt_pk_bf16_f32 v11, v110, v111
    v_dot2c_f32_bf16 v20, v8, v24
    v_dot2c_f32_bf16 v22, v8, v8
    v_dot2c_f32_bf16 v20, v9, v24
    v_dot2c_f32_bf16 v22, v9, v9
    v_dot2c_f32_bf16 v20, v10, v24
    v_dot2c_f32_bf16 v22, v10, v10
    v_dot2c_f32_bf16 v20, v11, v24
    v_dot2c_f32_bf16 v22, v11, v11
    s_nop 0
    s_nop 1
    v_add_f32_dpp v20, v20, v20 quad_perm:[1,0,3,2] row_mask:0xf bank_mask:0xf
    v_add_f32_dpp v22, v22, v22 quad_perm:[1,0,3,2] row_mask:0xf bank_mask:0xf
    s_nop 1
    v_add_f32_dpp v20, v20, v20 quad_perm:[2,3,0,1] row_mask:0xf bank_mask:0xf
    v_add_f32_dpp v22, v22, v22 quad_perm:[2,3,0,1] row_mask:0xf bank_mask:0xf
    s_nop 1
    v_add_f32_dpp v20, v20, v20 row_half_mirror row_mask:0xf bank_mask:0xf
    v_add_f32_dpp v22, v22, v22 row_half_mirror row_mask:0xf bank_mask:0xf
    s_mov_b64 exec, s[62:63]
    s_cmp_eq_u32 s56, 1
    s_cbranch_scc1 L60
    buffer_store_dwordx4 v[20:23], v16, s[16:19], s67 offen sc1
    s_branch L61
L60:
    buffer_store_dwordx4 v[20:23], v16, s[16:19], s67 offen
L61:
    s_mov_b64 exec, -1
    ds_read_b64_tr_b16 v[128:129], v19 offset:0
    ds_read_b64_tr_b16 v[130:131], v19 offset:256
    ds_read_b64_tr_b16 v[132:133], v19 offset:8192
    ds_read_b64_tr_b16 v[134:135], v19 offset:8448
    ds_read_b64_tr_b16 v[136:137], v19 offset:16384
    ds_read_b64_tr_b16 v[138:139], v19 offset:16640
    ds_read_b64_tr_b16 v[140:141], v19 offset:24576
    ds_read_b64_tr_b16 v[142:143], v19 offset:24832
    v_lshlrev_b32 v80, 16, v8
    v_and_b32 v81, 0xffff0000, v8
    v_lshlrev_b32 v82, 16, v9
    v_and_b32 v83, 0xffff0000, v9
    v_lshlrev_b32 v84, 16, v10
    v_and_b32 v85, 0xffff0000, v10
    v_lshlrev_b32 v86, 16, v11
    v_and_b32 v87, 0xffff0000, v11
L62:
    buffer_load_dwordx4 v[68:71], v17, s[16:19], s68 offen sc1
    s_waitcnt vmcnt(0)
    v_and_b32 v72, v69, v71
    v_cmp_ne_u32 vcc, 1, v72
    s_cbranch_vccz L63
    s_sub_u32 s66, s66, 1
    s_cmp_lg_u32 s66, 0
    s_cbranch_scc1 L62
L63:
    s_nop 1
    v_add_f32_dpp v68, v68, v68 quad_perm:[1,0,3,2] row_mask:0xf bank_mask:0xf
    v_add_f32_dpp v70, v70, v70 quad_perm:[1,0,3,2] row_mask:0xf bank_mask:0xf
    s_nop 1
    v_add_f32_dpp v68, v68, v68 quad_perm:[2,3,0,1] row_mask:0xf bank_mask:0xf
    v_add_f32_dpp v70, v70, v70 quad_perm:[2,3,0,1] row_mask:0xf bank_mask:0xf
    s_nop 1
    v_add_f32_dpp v68, v68, v68 row_half_mirror row_mask:0xf bank_mask:0xf
    v_add_f32_dpp v70, v70, v70 row_half_mirror row_mask:0xf bank_mask:0xf
    v_mul_f32 v68, 0x3b000000, v68
    v_mul_f32 v70, 0x3b000000, v70
    v_fma_f32 v70, -v68, v68, v70
    v_max_f32 v70, 0, v70
    v_mov_b32 v71, 0x2edbe6ff
    v_fmac_f32 v71, 0x3f800054, v70
    v_rsq_f32 v70, v71
    s_nop 0
    v_mul_f32 v72, v68, v70
    v_sub_f32 v72, 0, v72
    v_mov_b32 v71, v70
    v_mov_b32 v73, v72
    v_pk_fma_f32 v[80:81], v[80:81], v[70:71], v[72:73]
    v_pk_fma_f32 v[82:83], v[82:83], v[70:71], v[72:73]
    v_pk_fma_f32 v[84:85], v[84:85], v[70:71], v[72:73]
    v_pk_fma_f32 v[86:87], v[86:87], v[70:71], v[72:73]
    v_cvt_pk_bf16_f32 v76, v80, v81
    v_cvt_pk_bf16_f32 v77, v82, v83
    v_cvt_pk_bf16_f32 v78, v84, v85
    v_cvt_pk_bf16_f32 v79, v86, v87
    buffer_store_dwordx4 v[76:79], v18, s[16:19], s69 offen sc1
    ds_read_b64_tr_b16 v[32:33], v13 offset:32768
    ds_read_b64_tr_b16 v[34:35], v13 offset:33024
    ds_read_b64_tr_b16 v[36:37], v13 offset:40960
    ds_read_b64_tr_b16 v[38:39], v13 offset:41216
    ds_read_b64_tr_b16 v[40:41], v13 offset:49152
    ds_read_b64_tr_b16 v[42:43], v13 offset:49408
    ds_read_b64_tr_b16 v[44:45], v13 offset:57344
    ds_read_b64_tr_b16 v[46:47], v13 offset:57600
    s_waitcnt lgkmcnt(0)
    s_add_u32 m0, s55, 65536
    s_add_u32 s60, s54, 524288
    buffer_load_dwordx4 v12, s[28:31], s60 offen lds
    s_add_u32 m0, s55, 73728
    s_add_u32 s60, s54, 589824
    buffer_load_dwordx4 v12, s[28:31], s60 offen lds
    s_waitcnt vmcnt(2)
    s_barrier
    s_cmp_lg_u32 s50, 0
    s_cbranch_scc1 L64
    s_lshl_b32 s60, s49, 10
    s_add_u32 s60, s60, 8192
    s_add_u32 s60, s60, s53
    v_mov_b32 v16, 1
    v_lshlrev_b32 v17, 7, v1
    s_mov_b64 exec, 255
    buffer_atomic_add v16, v17, s[16:19], s60 offen sc1
    s_mov_b64 exec, -1
L64:
    s_cmp_lg_u32 s51, 0
    s_cbranch_scc1 L65
    v_mov_b32 v72, -1
    v_mov_b32 v73, -1
    v_mov_b32 v74, -1
    v_mov_b32 v75, -1
    s_add_u32 s60, s88, 16777216
    buffer_store_dwordx4 v[72:75], v4, s[16:19], s60 offen sc1
L65:
    s_add_u32 m0, s55, 81920
    s_add_u32 s60, s54, 655360
    buffer_load_dwordx4 v12, s[28:31], s60 offen lds
    s_add_u32 m0, s55, 90112
    s_add_u32 s60, s54, 720896
    buffer_load_dwordx4 v12, s[28:31], s60 offen lds
    s_add_u32 m0, s55, 32768
    s_add_u32 s60, s54, 262144
    buffer_load_dwordx4 v12, s[28:31], s60 offen lds
    s_add_u32 m0, s55, 40960
    s_add_u32 s60, s54, 327680
    buffer_load_dwordx4 v12, s[28:31], s60 offen lds
    s_add_u32 m0, s55, 49152
    s_add_u32 s60, s54, 393216
    buffer_load_dwordx4 v12, s[28:31], s60 offen lds
    s_add_u32 m0, s55, 57344
    s_add_u32 s60, s54, 458752
    buffer_load_dwordx4 v12, s[28:31], s60 offen lds
    s_add_u32 m0, s55, 0
    s_add_u32 s60, s54, 1572864
    buffer_load_dwordx4 v12, s[28:31], s60 offen lds
    s_add_u32 m0, s55, 8192
    s_add_u32 s60, s54, 1638400
    buffer_load_dwordx4 v12, s[28:31], s60 offen lds
    s_add_u32 m0, s55, 16384
    s_add_u32 s60, s54, 1703936
    buffer_load_dwordx4 v12, s[28:31], s60 offen lds
    s_add_u32 m0, s55, 24576
    s_add_u32 s60, s54, 1769472
    buffer_load_dwordx4 v12, s[28:31], s60 offen lds
    v_lshlrev_b32 v21, 1, v2
    s_lshl_b32 s60, s48, 7
    buffer_load_ushort v18, v21, s[36:39], s60 offen
    s_lshr_b32 s60, s50, 1
    s_and_b32 s61, s50, 1
    s_lshl_b32 s61, s61, 11
    s_add_u32 s61, s61, s52
    s_mul_i32 s65, s49, 229376
    s_mul_i32 s63, s60, 28672
    s_add_u32 s65, s65, s63
    s_add_u32 s65, s65, s61
    s_add_u32 s65, s65, 8388608
    s_lshl_b32 s62, s49, 18
    s_lshl_b32 s63, s60, 15
    s_add_u32 s62, s62, s63
    s_add_u32 s62, s62, s61
    s_add_u32 s62, s62, 6291456
    s_mul_i32 s67, s49, 229376
    s_lshl_b32 s63, s48, 12
    s_add_u32 s67, s67, s63
    s_lshl_b32 s63, s60, 9
    s_add_u32 s67, s67, s63
    s_add_u32 s67, s67, s61
    s_add_u32 s67, s67, 8388608
    s_lshl_b32 s63, s50, 11
    s_lshl_b32 s60, s60, 12
    v_bfe_u32 v16, v1, 3, 2
    v_lshlrev_b32 v22, 9, v16
    v_and_b32 v16, 3, v1
    v_lshl_add_u32 v22, v16, 7, v22
    v_bfe_u32 v16, v1, 2, 1
    v_lshl_add_u32 v22, v16, 6, v22
    v_bfe_u32 v16, v1, 1, 1
    v_bfe_u32 v17, v1, 4, 1
    v_lshl_add_u32 v16, v17, 1, v16
    v_lshrrev_b32 v17, 5, v1
    v_xor_b32 v16, v16, v17
    v_lshl_add_u32 v22, v16, 4, v22
    v_add_u32 v22, s60, v22
    v_xor_b32 v23, 32, v22
    s_sub_u32 s60, s60, s55
    s_sub_u32 s60, s60, 32768
    v_add_u32 v28, s60, v13
    s_and_b32 s60, s50, 1
    s_lshl_b32 s60, s60, 11
    v_add_u32 v31, s60, v28
    s_lshl_b32 s66, s83, 12
    s_mul_i32 s64, s50, 24576
    s_lshl_b32 s60, s49, 7
    s_add_u32 s64, s64, s60
    s_lshl_b32 s68, s49, 10
    s_add_u32 s68, s68, 16384
    s_add_u32 s68, s68, s53
    s_lshr_b32 s61, s48, 2
    s_lshl_b32 s61, s61, 7
    s_add_u32 s68, s68, s61
    s_lshl_b32 s69, s49, 10
    s_add_u32 s69, s69, 32768
    s_add_u32 s69, s69, s53
    s_lshr_b32 s61, s48, 2
    s_lshl_b32 s61, s61, 7
    s_add_u32 s69, s69, s61
    s_cmp_ge_u32 s48, 28
    s_cbranch_scc1 L66
    s_and_b32 s60, s50, 1
    s_lshr_b32 s61, s50, 1
    s_lshl_b32 s72, s60, 14
    s_add_u32 s72, s72, 65536
    s_lshl_b32 s70, s61, 10
    s_add_u32 s70, s70, s72
    v_add_u32 v21, s70, v4
    s_lshl_b32 s70, s61, 12
    s_add_u32 s72, s72, s70
    s_lshl_b32 s60, s60, 6
    s_lshl_b32 s70, s48, 7
    s_add_u32 s60, s60, s70
    v_lshlrev_b32 v16, 3, v3
    buffer_load_dwordx2 v[26:27], v16, s[32:35], s60 offen
    v_lshrrev_b32 v17, 5, v1
    s_lshr_b32 s61, s61, 1
    s_lshl_b32 s61, s61, 1
    v_or_b32 v17, s61, v17
    v_lshlrev_b32 v17, 4, v17
    v_lshlrev_b32 v20, 3, v1
    v_xor_b32 v20, v20, v17
    s_mov_b32 s71, 0xbdd2d3e8
    v_mov_b32 v29, 0xc0135761
    s_cmp_lg_u32 s50, 0
    s_cbranch_scc1 L68
    s_lshl_b32 s60, s49, 10
    s_add_u32 s60, s60, 8192
    s_add_u32 s60, s60, s53
    s_lshr_b32 s61, s48, 2
    s_lshl_b32 s61, s61, 7
    s_add_u32 s60, s60, s61
    s_mov_b64 exec, 1
    s_mov_b32 s61, 200000
L69:
    buffer_load_dword v16, v4, s[16:19], s60 offen sc1
    s_waitcnt vmcnt(0)
    v_cmp_ne_u32 vcc, 32, v16
    s_cbranch_vccz L70
    s_sub_u32 s61, s61, 1
    s_cmp_lg_u32 s61, 0
    s_cbranch_scc1 L69
L70:
    s_mov_b64 exec, -1
L68:
    s_barrier
    s_add_u32 s60, s66, 0
    s_and_b32 s60, s60, 0x7fff
    s_add_u32 s60, s60, s62
    s_add_u32 m0, s63, 0
    s_nop 0
    buffer_load_dwordx4 v4, s[16:19], s60 offen sc1 lds
    buffer_load_dwordx4 v4, s[16:19], s60 offen offset:1024 sc1 lds
    s_add_u32 s60, s66, 4096
    s_and_b32 s60, s60, 0x7fff
    s_add_u32 s60, s60, s62
    s_add_u32 m0, s63, 16384
    s_nop 0
    buffer_load_dwordx4 v4, s[16:19], s60 offen sc1 lds
    buffer_load_dwordx4 v4, s[16:19], s60 offen offset:1024 sc1 lds
    s_add_u32 s60, s66, 8192
    s_and_b32 s60, s60, 0x7fff
    s_add_u32 s60, s60, s62
    s_add_u32 m0, s63, 32768
    s_nop 0
    buffer_load_dwordx4 v4, s[16:19], s60 offen sc1 lds
    buffer_load_dwordx4 v4, s[16:19], s60 offen offset:1024 sc1 lds
    s_add_u32 s60, s66, 12288
    s_and_b32 s60, s60, 0x7fff
    s_add_u32 s60, s60, s62
    s_add_u32 m0, s63, 49152
    s_nop 0
    buffer_load_dwordx4 v4, s[16:19], s60 offen sc1 lds
    buffer_load_dwordx4 v4, s[16:19], s60 offen offset:1024 sc1 lds
    s_waitcnt vmcnt(6) lgkmcnt(0)
    s_barrier
    v_subrev_u32 v17, 32768, v13
    ds_read_b64_tr_b16 v[80:81], v28 offset:0
    ds_read_b64_tr_b16 v[82:83], v28 offset:256
    ds_read_b64_tr_b16 v[84:85], v28 offset:1024
    ds_read_b64_tr_b16 v[86:87], v28 offset:1280
    v_lshlrev_b32 v24, 16, v26
    ds_read_b64_tr_b16 v[88:89], v28 offset:2048
    ds_read_b64_tr_b16 v[90:91], v28 offset:2304
    ds_read_b64_tr_b16 v[92:93], v28 offset:3072
    ds_read_b64_tr_b16 v[94:95], v28 offset:3328
    v_and_b32 v25, 0xffff0000, v26
    ds_read_b64_tr_b16 v[112:113], v17 offset:0
    ds_read_b64_tr_b16 v[114:115], v17 offset:256
    ds_read_b64_tr_b16 v[116:117], v17 offset:8192
    ds_read_b64_tr_b16 v[118:119], v17 offset:8448
    v_lshlrev_b32 v26, 16, v27
    ds_read_b64_tr_b16 v[120:121], v17 offset:16384
    ds_read_b64_tr_b16 v[122:123], v17 offset:16640
    ds_read_b64_tr_b16 v[124:125], v17 offset:24576
    ds_read_b64_tr_b16 v[126:127], v17 offset:24832
    v_and_b32 v27, 0xffff0000, v27
    s_waitcnt vmcnt(4) lgkmcnt(0)
    s_barrier
    v_mfma_f32_32x32x16_bf16 v[48:63], v[80:83], a[0:3], 0
    ds_read_b64_tr_b16 v[96:97], v28 offset:16384
    ds_read_b64_tr_b16 v[98:99], v28 offset:16640
    ds_read_b64_tr_b16 v[100:101], v28 offset:17408
    v_mfma_f32_32x32x16_bf16 v[48:63], v[84:87], a[4:7], v[48:63]
    ds_read_b64_tr_b16 v[102:103], v28 offset:17664
    ds_read_b64_tr_b16 v[104:105], v28 offset:18432
    ds_read_b64_tr_b16 v[106:107], v28 offset:18688
    v_mfma_f32_32x32x16_bf16 v[48:63], v[88:91], a[8:11], v[48:63]
    ds_read_b64_tr_b16 v[108:109], v28 offset:19456
    ds_read_b64_tr_b16 v[110:111], v28 offset:19712
    v_mfma_f32_32x32x16_bf16 v[48:63], v[92:95], a[12:15], v[48:63]
    s_add_u32 s60, s66, 16384
    s_and_b32 s60, s60, 0x7fff
    s_add_u32 s60, s60, s62
    s_add_u32 m0, s63, 0
    s_nop 0
    buffer_load_dwordx4 v4, s[16:19], s60 offen sc1 lds
    buffer_load_dwordx4 v4, s[16:19], s60 offen offset:1024 sc1 lds
    s_waitcnt vmcnt(4) lgkmcnt(0)
    s_barrier
    v_mfma_f32_32x32x16_bf16 v[48:63], v[96:99], a[16:19], v[48:63]
    ds_read_b64_tr_b16 v[80:81], v28 offset:32768
    ds_read_b64_tr_b16 v[82:83], v28 offset:33024
    ds_read_b64_tr_b16 v[84:85], v28 offset:33792
    v_mfma_f32_32x32x16_bf16 v[48:63], v[100:103], a[20:23], v[48:63]
    ds_read_b64_tr_b16 v[86:87], v28 offset:34048
    ds_read_b64_tr_b16 v[88:89], v28 offset:34816
    ds_read_b64_tr_b16 v[90:91], v28 offset:35072
    v_mfma_f32_32x32x16_bf16 v[48:63], v[104:107], a[24:27], v[48:63]
    ds_read_b64_tr_b16 v[92:93], v28 offset:35840
    ds_read_b64_tr_b16 v[94:95], v28 offset:36096
    v_mfma_f32_32x32x16_bf16 v[48:63], v[108:111], a[28:31], v[48:63]
    s_add_u32 s60, s66, 20480
    s_and_b32 s60, s60, 0x7fff
    s_add_u32 s60, s60, s62
    s_add_u32 m0, s63, 16384
    s_nop 0
    buffer_load_dwordx4 v4, s[16:19], s60 offen sc1 lds
    buffer_load_dwordx4 v4, s[16:19], s60 offen offset:1024 sc1 lds
    s_waitcnt vmcnt(4) lgkmcnt(0)
    s_barrier
    v_mfma_f32_32x32x16_bf16 v[48:63], v[80:83], a[32:35], v[48:63]
    ds_read_b64_tr_b16 v[96:97], v28 offset:49152
    ds_read_b64_tr_b16 v[98:99], v28 offset:49408
    ds_read_b64_tr_b16 v[100:101], v28 offset:50176
    v_mfma_f32_32x32x16_bf16 v[48:63], v[84:87], a[36:39], v[48:63]
    ds_read_b64_tr_b16 v[102:103], v28 offset:50432
    ds_read_b64_tr_b16 v[104:105], v28 offset:51200
    ds_read_b64_tr_b16 v[106:107], v28 offset:51456
    v_mfma_f32_32x32x16_bf16 v[48:63], v[88:91], a[40:43], v[48:63]
    ds_read_b64_tr_b16 v[108:109], v28 offset:52224
    ds_read_b64_tr_b16 v[110:111], v28 offset:52480
    v_mfma_f32_32x32x16_bf16 v[48:63], v[92:95], a[44:47], v[48:63]
    s_add_u32 s60, s66, 24576
    s_and_b32 s60, s60, 0x7fff
    s_add_u32 s60, s60, s62
    s_add_u32 m0, s63, 32768
    s_nop 0
    buffer_load_dwordx4 v4, s[16:19], s60 offen sc1 lds
    buffer_load_dwordx4 v4, s[16:19], s60 offen offset:1024 sc1 lds
    s_waitcnt vmcnt(4) lgkmcnt(0)
    s_barrier
    v_mfma_f32_32x32x16_bf16 v[48:63], v[96:99], a[48:51], v[48:63]
    ds_read_b64_tr_b16 v[80:81], v28 offset:0
    ds_read_b64_tr_b16 v[82:83], v28 offset:256
    ds_read_b64_tr_b16 v[84:85], v28 offset:1024
    v_mfma_f32_32x32x16_bf16 v[48:63], v[100:103], a[52:55], v[48:63]
    ds_read_b64_tr_b16 v[86:87], v28 offset:1280
    ds_read_b64_tr_b16 v[88:89], v28 offset:2048
    ds_read_b64_tr_b16 v[90:91], v28 offset:2304
    v_mfma_f32_32x32x16_bf16 v[48:63], v[104:107], a[56:59], v[48:63]
    ds_read_b64_tr_b16 v[92:93], v28 offset:3072
    ds_read_b64_tr_b16 v[94:95], v28 offset:3328
    v_mfma_f32_32x32x16_bf16 v[48:63], v[108:111], a[60:63], v[48:63]
    s_add_u32 s60, s66, 28672
    s_and_b32 s60, s60, 0x7fff
    s_add_u32 s60, s60, s62
    s_add_u32 m0, s63, 49152
    s_nop 0
    buffer_load_dwordx4 v4, s[16:19], s60 offen sc1 lds
    buffer_load_dwordx4 v4, s[16:19], s60 offen offset:1024 sc1 lds
    s_waitcnt vmcnt(4) lgkmcnt(0)
    s_barrier
    v_mfma_f32_32x32x16_bf16 v[48:63], v[80:83], a[64:67], v[48:63]
    ds_read_b64_tr_b16 v[96:97], v28 offset:16384
    ds_read_b64_tr_b16 v[98:99], v28 offset:16640
    ds_read_b64_tr_b16 v[100:101], v28 offset:17408
    v_mfma_f32_32x32x16_bf16 v[48:63], v[84:87], a[68:71], v[48:63]
    ds_read_b64_tr_b16 v[102:103], v28 offset:17664
    ds_read_b64_tr_b16 v[104:105], v28 offset:18432
    ds_read_b64_tr_b16 v[106:107], v28 offset:18688
    v_mfma_f32_32x32x16_bf16 v[48:63], v[88:91], a[72:75], v[48:63]
    ds_read_b64_tr_b16 v[108:109], v28 offset:19456
    ds_read_b64_tr_b16 v[110:111], v28 offset:19712
    v_mfma_f32_32x32x16_bf16 v[48:63], v[92:95], a[76:79], v[48:63]
    s_add_u32 s60, s66, 0
    s_and_b32 s60, s60, 0x7fff
    s_add_u32 s60, s60, s62
    s_add_u32 m0, s63, 0
    s_add_u32 s60, s60, 131072
    buffer_load_dwordx4 v4, s[16:19], s60 offen sc1 lds
    buffer_load_dwordx4 v4, s[16:19], s60 offen offset:1024 sc1 lds
    s_waitcnt vmcnt(4) lgkmcnt(0)
    s_barrier
    v_mfma_f32_32x32x16_bf16 v[48:63], v[96:99], a[80:83], v[48:63]
    ds_read_b64_tr_b16 v[80:81], v28 offset:32768
    ds_read_b64_tr_b16 v[82:83], v28 offset:33024
    ds_read_b64_tr_b16 v[84:85], v28 offset:33792
    v_mfma_f32_32x32x16_bf16 v[48:63], v[100:103], a[84:87], v[48:63]
    ds_read_b64_tr_b16 v[86:87], v28 offset:34048
    ds_read_b64_tr_b16 v[88:89], v28 offset:34816
    ds_read_b64_tr_b16 v[90:91], v28 offset:35072
    v_mfma_f32_32x32x16_bf16 v[48:63], v[104:107], a[88:91], v[48:63]
    ds_read_b64_tr_b16 v[92:93], v28 offset:35840
    ds_read_b64_tr_b16 v[94:95], v28 offset:36096
    v_mfma_f32_32x32x16_bf16 v[48:63], v[108:111], a[92:95], v[48:63]
    s_add_u32 s60, s66, 4096
    s_and_b32 s60, s60, 0x7fff
    s_add_u32 s60, s60, s62
    s_add_u32 m0, s63, 16384
    s_add_u32 s60, s60, 131072
    buffer_load_dwordx4 v4, s[16:19], s60 offen sc1 lds
    buffer_load_dwordx4 v4, s[16:19], s60 offen offset:1024 sc1 lds
    s_waitcnt vmcnt(4) lgkmcnt(0)
    s_barrier
    v_mfma_f32_32x32x16_bf16 v[48:63], v[80:83], a[96:99], v[48:63]
    ds_read_b64_tr_b16 v[96:97], v28 offset:49152
    ds_read_b64_tr_b16 v[98:99], v28 offset:49408
    ds_read_b64_tr_b16 v[100:101], v28 offset:50176
    v_mfma_f32_32x32x16_bf16 v[48:63], v[84:87], a[100:103], v[48:63]
    ds_read_b64_tr_b16 v[102:103], v28 offset:50432
    ds_read_b64_tr_b16 v[104:105], v28 offset:51200
    ds_read_b64_tr_b16 v[106:107], v28 offset:51456
    v_mfma_f32_32x32x16_bf16 v[48:63], v[88:91], a[104:107], v[48:63]
    ds_read_b64_tr_b16 v[108:109], v28 offset:52224
    ds_read_b64_tr_b16 v[110:111], v28 offset:52480
    v_mfma_f32_32x32x16_bf16 v[48:63], v[92:95], a[108:111], v[48:63]
    s_add_u32 s60, s66, 8192
    s_and_b32 s60, s60, 0x7fff
    s_add_u32 s60, s60, s62
    s_add_u32 m0, s63, 32768
    s_add_u32 s60, s60, 131072
    buffer_load_dwordx4 v4, s[16:19], s60 offen sc1 lds
    buffer_load_dwordx4 v4, s[16:19], s60 offen offset:1024 sc1 lds
    s_waitcnt vmcnt(4) lgkmcnt(0)
    s_barrier
    v_mfma_f32_32x32x16_bf16 v[48:63], v[96:99], v[128:131], v[48:63]
    ds_read_b64_tr_b16 v[80:81], v28 offset:0
    ds_read_b64_tr_b16 v[82:83], v28 offset:256
    ds_read_b64_tr_b16 v[84:85], v28 offset:1024
    v_mfma_f32_32x32x16_bf16 v[48:63], v[100:103], v[132:135], v[48:63]
    ds_read_b64_tr_b16 v[86:87], v28 offset:1280
    ds_read_b64_tr_b16 v[88:89], v28 offset:2048
    ds_read_b64_tr_b16 v[90:91], v28 offset:2304
    v_mfma_f32_32x32x16_bf16 v[48:63], v[104:107], v[136:139], v[48:63]
    ds_read_b64_tr_b16 v[92:93], v28 offset:3072
    ds_read_b64_tr_b16 v[94:95], v28 offset:3328
    v_mfma_f32_32x32x16_bf16 v[48:63], v[108:111], v[140:143], v[48:63]
    s_add_u32 s60, s66, 12288
    s_and_b32 s60, s60, 0x7fff
    s_add_u32 s60, s60, s62
    s_add_u32 m0, s63, 49152
    s_add_u32 s60, s60, 131072
    buffer_load_dwordx4 v4, s[16:19], s60 offen sc1 lds
    buffer_load_dwordx4 v4, s[16:19], s60 offen offset:1024 sc1 lds
    s_waitcnt vmcnt(4) lgkmcnt(0)
    s_barrier
    v_mfma_f32_32x32x16_bf16 v[64:79], v[80:83], a[0:3], 0
    ds_read_b64_tr_b16 v[96:97], v28 offset:16384
    ds_read_b64_tr_b16 v[98:99], v28 offset:16640
    ds_read_b64_tr_b16 v[100:101], v28 offset:17408
    ds_read_b64_tr_b16 v[102:103], v28 offset:17664
    ds_read_b64_tr_b16 v[104:105], v28 offset:18432
    ds_read_b64_tr_b16 v[106:107], v28 offset:18688
    v_mfma_f32_32x32x16_bf16 v[64:79], v[84:87], a[4:7], v[64:79]
    ds_read_b64_tr_b16 v[108:109], v28 offset:19456
    ds_read_b64_tr_b16 v[110:111], v28 offset:19712
    s_sub_u32 m0, s72, 61440
    s_nop 0
    ds_write_addtid_b32 v48 offset:61440
    ds_write_addtid_b32 v49 offset:61696
    ds_write_addtid_b32 v50 offset:61952
    ds_write_addtid_b32 v51 offset:62208
    v_mfma_f32_32x32x16_bf16 v[64:79], v[88:91], a[8:11], v[64:79]
    ds_write_addtid_b32 v52 offset:62464
    ds_write_addtid_b32 v53 offset:62720
    ds_write_addtid_b32 v54 offset:62976
    ds_write_addtid_b32 v55 offset:63232
    s_sub_u32 m0, s72, 61440
    s_nop 0
    ds_write_addtid_b32 v56 offset:63488
    ds_write_addtid_b32 v57 offset:63744
    v_mfma_f32_32x32x16_bf16 v[64:79], v[92:95], a[12:15], v[64:79]
    ds_write_addtid_b32 v58 offset:64000
    ds_write_addtid_b32 v59 offset:64256
    ds_write_addtid_b32 v60 offset:64512
    ds_write_addtid_b32 v61 offset:64768
    ds_write_addtid_b32 v62 offset:65024
    ds_write_addtid_b32 v63 offset:65280
    s_add_u32 s60, s66, 16384
    s_and_b32 s60, s60, 0x7fff
    s_add_u32 s60, s60, s62
    s_add_u32 m0, s63, 0
    s_add_u32 s60, s60, 131072
    buffer_load_dwordx4 v4, s[16:19], s60 offen sc1 lds
    buffer_load_dwordx4 v4, s[16:19], s60 offen offset:1024 sc1 lds
    s_waitcnt vmcnt(4) lgkmcnt(0)
    s_barrier
    v_mfma_f32_32x32x16_bf16 v[64:79], v[96:99], a[16:19], v[64:79]
    ds_read_b64_tr_b16 v[80:81], v28 offset:32768
    ds_read_b64_tr_b16 v[82:83], v28 offset:33024
    ds_read_b64_tr_b16 v[84:85], v28 offset:33792
    v_mfma_f32_32x32x16_bf16 v[64:79], v[100:103], a[20:23], v[64:79]
    ds_read_b64_tr_b16 v[86:87], v28 offset:34048
    ds_read_b64_tr_b16 v[88:89], v28 offset:34816
    ds_read_b64_tr_b16 v[90:91], v28 offset:35072
    v_mfma_f32_32x32x16_bf16 v[64:79], v[104:107], a[24:27], v[64:79]
    ds_read_b64_tr_b16 v[92:93], v28 offset:35840
    ds_read_b64_tr_b16 v[94:95], v28 offset:36096
    ds_read_b128 v[48:51], v21 offset:0
    v_mfma_f32_32x32x16_bf16 v[64:79], v[108:111], a[28:31], v[64:79]
    ds_read_b128 v[52:55], v21 offset:4096
    ds_read_b128 v[56:59], v21 offset:8192
    ds_read_b128 v[60:63], v21 offset:12288
    s_add_u32 s60, s66, 20480
    s_and_b32 s60, s60, 0x7fff
    s_add_u32 s60, s60, s62
    s_add_u32 m0, s63, 16384
    s_add_u32 s60, s60, 131072
    buffer_load_dwordx4 v4, s[16:19], s60 offen sc1 lds
    buffer_load_dwordx4 v4, s[16:19], s60 offen offset:1024 sc1 lds
    s_waitcnt vmcnt(4) lgkmcnt(0)
    s_barrier
    v_mfma_f32_32x32x16_bf16 v[64:79], v[80:83], a[32:35], v[64:79]
    ds_read_b64_tr_b16 v[96:97], v28 offset:49152
    ds_read_b64_tr_b16 v[98:99], v28 offset:49408
    ds_read_b64_tr_b16 v[100:101], v28 offset:50176
    ds_read_b64_tr_b16 v[102:103], v28 offset:50432
    v_add_f32 v48, v48, v52
    v_add_f32 v56, v56, v60
    v_add_f32 v49, v49, v53
    v_add_f32 v57, v57, v61
    v_add_f32 v50, v50, v54
    v_add_f32 v58, v58, v62
    v_add_f32 v51, v51, v55
    v_add_f32 v59, v59, v63
    v_add_f32 v48, v48, v24
    v_add_f32 v49, v49, v25
    v_add_f32 v50, v50, v26
    v_add_f32 v51, v51, v27
    v_mfma_f32_32x32x16_bf16 v[64:79], v[84:87], a[36:39], v[64:79]
    ds_read_b64_tr_b16 v[104:105], v28 offset:51200
    ds_read_b64_tr_b16 v[106:107], v28 offset:51456
    ds_read_b64_tr_b16 v[108:109], v28 offset:52224
    ds_read_b64_tr_b16 v[110:111], v28 offset:52480
    v_add_f32 v48, v48, v56
    v_add_f32 v49, v49, v57
    v_add_f32 v50, v50, v58
    v_add_f32 v51, v51, v59
    v_mul_f32 v52, v48, v48
    v_mul_f32 v53, v49, v49
    v_mul_f32 v54, v50, v50
    v_mul_f32 v55, v51, v51
    v_fma_f32 v52, v52, s71, v29
    v_fma_f32 v53, v53, s71, v29
    v_fma_f32 v54, v54, s71, v29
    v_fma_f32 v55, v55, s71, v29
    v_mfma_f32_32x32x16_bf16 v[64:79], v[88:91], a[40:43], v[64:79]
    ds_read_b64_tr_b16 a[0:1], v13 offset:0
    ds_read_b64_tr_b16 a[2:3], v13 offset:256
    ds_read_b64_tr_b16 a[4:5], v13 offset:8192
    ds_read_b64_tr_b16 a[6:7], v13 offset:8448
    v_mul_f32 v52, v52, v48
    v_mul_f32 v53, v53, v49
    v_mul_f32 v54, v54, v50
    v_mul_f32 v55, v55, v51
    v_exp_f32 v52, v52
    v_exp_f32 v53, v53
    v_exp_f32 v54, v54
    v_exp_f32 v55, v55
    v_add_f32 v52, 1.0, v52
    v_add_f32 v53, 1.0, v53
    v_add_f32 v54, 1.0, v54
    v_add_f32 v55, 1.0, v55
    v_mfma_f32_32x32x16_bf16 v[64:79], v[92:95], a[44:47], v[64:79]
    ds_read_b64_tr_b16 a[8:9], v13 offset:16384
    ds_read_b64_tr_b16 a[10:11], v13 offset:16640
    ds_read_b64_tr_b16 a[12:13], v13 offset:24576
    ds_read_b64_tr_b16 a[14:15], v13 offset:24832
    v_rcp_f32 v52, v52
    v_rcp_f32 v53, v53
    v_rcp_f32 v54, v54
    v_rcp_f32 v55, v55
    v_mul_f32 v48, v48, v52
    v_mul_f32 v49, v49, v53
    v_mul_f32 v50, v50, v54
    v_mul_f32 v51, v51, v55
    v_cvt_pk_bf16_f32 v56, v48, v49
    v_cvt_pk_bf16_f32 v57, v50, v51
    buffer_store_dwordx2 v[56:57], v20, s[16:19], s67 offen sc1
    s_add_u32 s60, s66, 24576
    s_and_b32 s60, s60, 0x7fff
    s_add_u32 s60, s60, s62
    s_add_u32 m0, s63, 32768
    s_add_u32 s60, s60, 131072
    buffer_load_dwordx4 v4, s[16:19], s60 offen sc1 lds
    buffer_load_dwordx4 v4, s[16:19], s60 offen offset:1024 sc1 lds
    s_waitcnt vmcnt(5) lgkmcnt(0)
    s_barrier
    v_mfma_f32_32x32x16_bf16 v[64:79], v[96:99], a[48:51], v[64:79]
    ds_read_b64_tr_b16 v[80:81], v28 offset:0
    ds_read_b64_tr_b16 v[82:83], v28 offset:256
    ds_read_b64_tr_b16 v[84:85], v28 offset:1024
    ds_read_b64_tr_b16 v[86:87], v28 offset:1280
    v_mfma_f32_32x32x16_bf16 v[64:79], v[100:103], a[52:55], v[64:79]
    ds_read_b64_tr_b16 v[88:89], v28 offset:2048
    ds_read_b64_tr_b16 v[90:91], v28 offset:2304
    ds_read_b64_tr_b16 v[92:93], v28 offset:3072
    ds_read_b64_tr_b16 v[94:95], v28 offset:3328
    v_mfma_f32_32x32x16_bf16 v[64:79], v[104:107], a[56:59], v[64:79]
    ds_read_b64_tr_b16 a[16:17], v13 offset:32768
    ds_read_b64_tr_b16 a[18:19], v13 offset:33024
    ds_read_b64_tr_b16 a[20:21], v13 offset:40960
    ds_read_b64_tr_b16 a[22:23], v13 offset:41216
    v_mfma_f32_32x32x16_bf16 v[64:79], v[108:111], a[60:63], v[64:79]
    ds_read_b64_tr_b16 a[24:25], v13 offset:49152
    ds_read_b64_tr_b16 a[26:27], v13 offset:49408
    ds_read_b64_tr_b16 a[28:29], v13 offset:57344
    ds_read_b64_tr_b16 a[30:31], v13 offset:57600
    s_add_u32 s60, s66, 28672
    s_and_b32 s60, s60, 0x7fff
    s_add_u32 s60, s60, s62
    s_add_u32 m0, s63, 49152
    s_add_u32 s60, s60, 131072
    buffer_load_dwordx4 v4, s[16:19], s60 offen sc1 lds
    buffer_load_dwordx4 v4, s[16:19], s60 offen offset:1024 sc1 lds
    s_waitcnt vmcnt(5) lgkmcnt(0)
    s_barrier
    v_mfma_f32_32x32x16_bf16 v[64:79], v[80:83], a[64:67], v[64:79]
    ds_read_b64_tr_b16 v[96:97], v28 offset:16384
    ds_read_b64_tr_b16 v[98:99], v28 offset:16640
    ds_read_b64_tr_b16 v[100:101], v28 offset:17408
    v_mfma_f32_32x32x16_bf16 v[64:79], v[84:87], a[68:71], v[64:79]
    ds_read_b64_tr_b16 v[102:103], v28 offset:17664
    ds_read_b64_tr_b16 v[104:105], v28 offset:18432
    ds_read_b64_tr_b16 v[106:107], v28 offset:18688
    v_mfma_f32_32x32x16_bf16 v[64:79], v[88:91], a[72:75], v[64:79]
    ds_read_b64_tr_b16 v[108:109], v28 offset:19456
    ds_read_b64_tr_b16 v[110:111], v28 offset:19712
    v_mfma_f32_32x32x16_bf16 v[64:79], v[92:95], a[76:79], v[64:79]
    s_add_u32 m0, s55, 32768
    s_add_u32 s60, s54, 786432
    buffer_load_dwordx4 v12, s[28:31], s60 offen lds
    s_waitcnt vmcnt(3) lgkmcnt(0)
    s_barrier
    v_mfma_f32_32x32x16_bf16 v[64:79], v[96:99], a[80:83], v[64:79]
    ds_read_b64_tr_b16 v[80:81], v28 offset:32768
    ds_read_b64_tr_b16 v[82:83], v28 offset:33024
    ds_read_b64_tr_b16 v[84:85], v28 offset:33792
    v_mfma_f32_32x32x16_bf16 v[64:79], v[100:103], a[84:87], v[64:79]
    ds_read_b64_tr_b16 v[86:87], v28 offset:34048
    ds_read_b64_tr_b16 v[88:89], v28 offset:34816
    ds_read_b64_tr_b16 v[90:91], v28 offset:35072
    v_mfma_f32_32x32x16_bf16 v[64:79], v[104:107], a[88:91], v[64:79]
    ds_read_b64_tr_b16 v[92:93], v28 offset:35840
    ds_read_b64_tr_b16 v[94:95], v28 offset:36096
    v_mfma_f32_32x32x16_bf16 v[64:79], v[108:111], a[92:95], v[64:79]
    s_cmp_lg_u32 s50, 0
    s_cbranch_scc1 L71
    s_lshl_b32 s60, s49, 10
    s_add_u32 s60, s60, 16384
    s_add_u32 s60, s60, s53
    v_mov_b32 v16, 1
    v_lshlrev_b32 v17, 7, v1
    s_mov_b64 exec, 255
    buffer_atomic_add v16, v17, s[16:19], s60 offen sc1
    s_mov_b64 exec, -1
L71:
    s_add_u32 m0, s55, 40960
    s_add_u32 s60, s54, 851968
    buffer_load_dwordx4 v12, s[28:31], s60 offen lds
    s_waitcnt vmcnt(2) lgkmcnt(0)
    s_barrier
    v_mfma_f32_32x32x16_bf16 v[64:79], v[80:83], a[96:99], v[64:79]
    ds_read_b64_tr_b16 v[96:97], v28 offset:49152
    ds_read_b64_tr_b16 v[98:99], v28 offset:49408
    ds_read_b64_tr_b16 v[100:101], v28 offset:50176
    v_mfma_f32_32x32x16_bf16 v[64:79], v[84:87], a[100:103], v[64:79]
    ds_read_b64_tr_b16 v[102:103], v28 offset:50432
    ds_read_b64_tr_b16 v[104:105], v28 offset:51200
    ds_read_b64_tr_b16 v[106:107], v28 offset:51456
    v_mfma_f32_32x32x16_bf16 v[64:79], v[88:91], a[104:107], v[64:79]
    ds_read_b64_tr_b16 v[108:109], v28 offset:52224
    ds_read_b64_tr_b16 v[110:111], v28 offset:52480
    v_mfma_f32_32x32x16_bf16 v[64:79], v[92:95], a[108:111], v[64:79]
    s_add_u32 m0, s55, 49152
    s_add_u32 s60, s54, 917504
    buffer_load_dwordx4 v12, s[28:31], s60 offen lds
    s_add_u32 m0, s55, 57344
    s_add_u32 s60, s54, 983040
    buffer_load_dwordx4 v12, s[28:31], s60 offen lds
    s_waitcnt lgkmcnt(0)
    v_mfma_f32_32x32x16_bf16 v[64:79], v[96:99], v[128:131], v[64:79]
    v_mfma_f32_32x32x16_bf16 v[64:79], v[100:103], v[132:135], v[64:79]
    v_mfma_f32_32x32x16_bf16 v[64:79], v[104:107], v[136:139], v[64:79]
    v_mfma_f32_32x32x16_bf16 v[64:79], v[108:111], v[140:143], v[64:79]
    s_nop 9
    s_sub_u32 m0, s72, 61440
    s_nop 0
    ds_write_addtid_b32 v64 offset:61440
    ds_write_addtid_b32 v65 offset:61696
    ds_write_addtid_b32 v66 offset:61952
    ds_write_addtid_b32 v67 offset:62208
    ds_write_addtid_b32 v68 offset:62464
    ds_write_addtid_b32 v69 offset:62720
    ds_write_addtid_b32 v70 offset:62976
    ds_write_addtid_b32 v71 offset:63232
    ds_write_addtid_b32 v72 offset:63488
    ds_write_addtid_b32 v73 offset:63744
    ds_write_addtid_b32 v74 offset:64000
    ds_write_addtid_b32 v75 offset:64256
    ds_write_addtid_b32 v76 offset:64512
    ds_write_addtid_b32 v77 offset:64768
    ds_write_addtid_b32 v78 offset:65024
    ds_write_addtid_b32 v79 offset:65280
    s_waitcnt lgkmcnt(0)
    s_barrier
    ds_read_b128 v[48:51], v21 offset:0
    ds_read_b128 v[52:55], v21 offset:4096
    ds_read_b128 v[56:59], v21 offset:8192
    ds_read_b128 v[60:63], v21 offset:12288
    s_add_u32 m0, s55, 65536
    s_add_u32 s60, s54, 1048576
    buffer_load_dwordx4 v12, s[28:31], s60 offen lds
    s_add_u32 m0, s55, 73728
    s_add_u32 s60, s54, 1114112
    buffer_load_dwordx4 v12, s[28:31], s60 offen lds
    s_add_u32 m0, s55, 81920
    s_add_u32 s60, s54, 1179648
    buffer_load_dwordx4 v12, s[28:31], s60 offen lds
    s_add_u32 m0, s55, 90112
    s_add_u32 s60, s54, 1245184
    buffer_load_dwordx4 v12, s[28:31], s60 offen lds
    s_mov_b64 exec, 1
    buffer_load_dword v19, v4, s[16:19], s68 offen sc1
    s_mov_b64 exec, -1
    s_waitcnt lgkmcnt(0)
    v_add_f32 v48, v48, v52
    v_add_f32 v56, v56, v60
    v_add_f32 v49, v49, v53
    v_add_f32 v57, v57, v61
    v_add_f32 v50, v50, v54
    v_add_f32 v58, v58, v62
    v_add_f32 v51, v51, v55
    v_add_f32 v59, v59, v63
    v_add_f32 v48, v48, v24
    v_add_f32 v49, v49, v25
    v_add_f32 v50, v50, v26
    v_add_f32 v51, v51, v27
    v_add_f32 v48, v48, v56
    v_add_f32 v49, v49, v57
    v_add_f32 v50, v50, v58
    v_add_f32 v51, v51, v59
    v_mul_f32 v52, v48, v48
    v_mul_f32 v53, v49, v49
    v_mul_f32 v54, v50, v50
    v_mul_f32 v55, v51, v51
    v_fma_f32 v52, v52, s71, v29
    v_fma_f32 v53, v53, s71, v29
    v_fma_f32 v54, v54, s71, v29
    v_fma_f32 v55, v55, s71, v29
    v_mul_f32 v52, v52, v48
    v_mul_f32 v53, v53, v49
    v_mul_f32 v54, v54, v50
    v_mul_f32 v55, v55, v51
    v_exp_f32 v52, v52
    v_exp_f32 v53, v53
    v_exp_f32 v54, v54
    v_exp_f32 v55, v55
    v_add_f32 v52, 1.0, v52
    v_add_f32 v53, 1.0, v53
    v_add_f32 v54, 1.0, v54
    v_add_f32 v55, 1.0, v55
    v_rcp_f32 v52, v52
    v_rcp_f32 v53, v53
    v_rcp_f32 v54, v54
    v_rcp_f32 v55, v55
    v_mul_f32 v48, v48, v52
    v_mul_f32 v49, v49, v53
    v_mul_f32 v50, v50, v54
    v_mul_f32 v51, v51, v55
    v_cvt_pk_bf16_f32 v56, v48, v49
    v_cvt_pk_bf16_f32 v57, v50, v51
    s_add_u32 s67, s67, 114688
    buffer_store_dwordx2 v[56:57], v20, s[16:19], s67 offen sc1
    s_waitcnt vmcnt(1)
    ds_read_b64_tr_b16 a[32:33], v13 offset:0
    ds_read_b64_tr_b16 a[34:35], v13 offset:256
    ds_read_b64_tr_b16 a[36:37], v13 offset:8192
    ds_read_b64_tr_b16 a[38:39], v13 offset:8448
    ds_read_b64_tr_b16 a[40:41], v13 offset:16384
    ds_read_b64_tr_b16 a[42:43], v13 offset:16640
    ds_read_b64_tr_b16 a[44:45], v13 offset:24576
    ds_read_b64_tr_b16 a[46:47], v13 offset:24832
    ds_read_b64_tr_b16 a[48:49], v13 offset:32768
    ds_read_b64_tr_b16 a[50:51], v13 offset:33024
    ds_read_b64_tr_b16 a[52:53], v13 offset:40960
    ds_read_b64_tr_b16 a[54:55], v13 offset:41216
    ds_read_b64_tr_b16 a[56:57], v13 offset:49152
    ds_read_b64_tr_b16 a[58:59], v13 offset:49408
    ds_read_b64_tr_b16 a[60:61], v13 offset:57344
    ds_read_b64_tr_b16 a[62:63], v13 offset:57600
    s_mov_b64 exec, 1
    s_mov_b32 s61, 200000
L72:
    v_cmp_ne_u32 vcc, 28, v19
    s_cbranch_vccz L73
    buffer_load_dword v19, v4, s[16:19], s68 offen sc1
    s_waitcnt vmcnt(0)
    s_sub_u32 s61, s61, 1
    s_cmp_lg_u32 s61, 0
    s_cbranch_scc1 L72
L73:
    s_mov_b64 exec, -1
    s_add_u32 m0, s63, 0
    s_add_u32 s60, s65, 0
    buffer_load_dwordx4 v4, s[16:19], s60 offen sc1 lds
    buffer_load_dwordx4 v4, s[16:19], s60 offen offset:1024 sc1 lds
    s_add_u32 m0, s63, 16384
    s_add_u32 s60, s65, 4096
    buffer_load_dwordx4 v4, s[16:19], s60 offen sc1 lds
    buffer_load_dwordx4 v4, s[16:19], s60 offen offset:1024 sc1 lds
    s_waitcnt vmcnt(4)
    s_barrier
    s_cmp_lg_u32 s50, 0
    s_cbranch_scc1 L74
    s_lshl_b32 s60, s49, 10
    s_add_u32 s60, s60, 32768
    s_add_u32 s60, s60, s53
    v_mov_b32 v16, 1
    v_lshlrev_b32 v17, 7, v1
    s_mov_b64 exec, 255
    buffer_atomic_add v16, v17, s[16:19], s60 offen sc1
    s_mov_b64 exec, -1
L74:
    s_branch L67
L66:
    s_waitcnt vmcnt(0)
    v_subrev_u32 v17, 32768, v13
    ds_read_b64_tr_b16 v[112:113], v17 offset:0
    ds_read_b64_tr_b16 v[114:115], v17 offset:256
    ds_read_b64_tr_b16 v[116:117], v17 offset:8192
    ds_read_b64_tr_b16 v[118:119], v17 offset:8448
    ds_read_b64_tr_b16 v[120:121], v17 offset:16384
    ds_read_b64_tr_b16 v[122:123], v17 offset:16640
    ds_read_b64_tr_b16 v[124:125], v17 offset:24576
    ds_read_b64_tr_b16 v[126:127], v17 offset:24832
    ds_read_b64_tr_b16 a[0:1], v13 offset:0
    ds_read_b64_tr_b16 a[2:3], v13 offset:256
    ds_read_b64_tr_b16 a[4:5], v13 offset:8192
    ds_read_b64_tr_b16 a[6:7], v13 offset:8448
    ds_read_b64_tr_b16 a[8:9], v13 offset:16384
    ds_read_b64_tr_b16 a[10:11], v13 offset:16640
    ds_read_b64_tr_b16 a[12:13], v13 offset:24576
    ds_read_b64_tr_b16 a[14:15], v13 offset:24832
    ds_read_b64_tr_b16 a[16:17], v13 offset:32768
    ds_read_b64_tr_b16 a[18:19], v13 offset:33024
    ds_read_b64_tr_b16 a[20:21], v13 offset:40960
    ds_read_b64_tr_b16 a[22:23], v13 offset:41216
    ds_read_b64_tr_b16 a[24:25], v13 offset:49152
    ds_read_b64_tr_b16 a[26:27], v13 offset:49408
    ds_read_b64_tr_b16 a[28:29], v13 offset:57344
    ds_read_b64_tr_b16 a[30:31], v13 offset:57600
    s_waitcnt lgkmcnt(0)
    s_add_u32 m0, s55, 32768
    s_add_u32 s60, s54, 786432
    buffer_load_dwordx4 v12, s[28:31], s60 offen lds
    s_add_u32 m0, s55, 40960
    s_add_u32 s60, s54, 851968
    buffer_load_dwordx4 v12, s[28:31], s60 offen lds
    s_add_u32 m0, s55, 49152
    s_add_u32 s60, s54, 917504
    buffer_load_dwordx4 v12, s[28:31], s60 offen lds
    s_add_u32 m0, s55, 57344
    s_add_u32 s60, s54, 983040
    buffer_load_dwordx4 v12, s[28:31], s60 offen lds
    s_add_u32 m0, s55, 65536
    s_add_u32 s60, s54, 1048576
    buffer_load_dwordx4 v12, s[28:31], s60 offen lds
    s_add_u32 m0, s55, 73728
    s_add_u32 s60, s54, 1114112
    buffer_load_dwordx4 v12, s[28:31], s60 offen lds
    s_add_u32 m0, s55, 81920
    s_add_u32 s60, s54, 1179648
    buffer_load_dwordx4 v12, s[28:31], s60 offen lds
    s_add_u32 m0, s55, 90112
    s_add_u32 s60, s54, 1245184
    buffer_load_dwordx4 v12, s[28:31], s60 offen lds
    s_waitcnt vmcnt(0)
    ds_read_b64_tr_b16 a[32:33], v13 offset:0
    ds_read_b64_tr_b16 a[34:35], v13 offset:256
    ds_read_b64_tr_b16 a[36:37], v13 offset:8192
    ds_read_b64_tr_b16 a[38:39], v13 offset:8448
    ds_read_b64_tr_b16 a[40:41], v13 offset:16384
    ds_read_b64_tr_b16 a[42:43], v13 offset:16640
    ds_read_b64_tr_b16 a[44:45], v13 offset:24576
    ds_read_b64_tr_b16 a[46:47], v13 offset:24832
    ds_read_b64_tr_b16 a[48:49], v13 offset:32768
    ds_read_b64_tr_b16 a[50:51], v13 offset:33024
    ds_read_b64_tr_b16 a[52:53], v13 offset:40960
    ds_read_b64_tr_b16 a[54:55], v13 offset:41216
    ds_read_b64_tr_b16 a[56:57], v13 offset:49152
    ds_read_b64_tr_b16 a[58:59], v13 offset:49408
    ds_read_b64_tr_b16 a[60:61], v13 offset:57344
    ds_read_b64_tr_b16 a[62:63], v13 offset:57600
    s_waitcnt lgkmcnt(0)
    v_mov_b32 v19, 28
    s_waitcnt vmcnt(0)
    s_cmp_lg_u32 s50, 0
    s_cbranch_scc1 L75
    s_lshl_b32 s60, s49, 10
    s_add_u32 s60, s60, 16384
    s_add_u32 s60, s60, s53
    s_lshr_b32 s61, s48, 2
    s_lshl_b32 s61, s61, 7
    s_add_u32 s60, s60, s61
    s_mov_b64 exec, 1
    s_mov_b32 s61, 200000
L76:
    buffer_load_dword v16, v4, s[16:19], s60 offen sc1
    s_waitcnt vmcnt(0)
    v_cmp_ne_u32 vcc, 28, v16
    s_cbranch_vccz L77
    s_sub_u32 s61, s61, 1
    s_cmp_lg_u32 s61, 0
    s_cbranch_scc1 L76
L77:
    s_mov_b64 exec, -1
L75:
    s_barrier
    s_add_u32 m0, s63, 0
    s_add_u32 s60, s65, 0
    buffer_load_dwordx4 v4, s[16:19], s60 offen sc1 lds
    buffer_load_dwordx4 v4, s[16:19], s60 offen offset:1024 sc1 lds
    s_add_u32 m0, s63, 16384
    s_add_u32 s60, s65, 4096
    buffer_load_dwordx4 v4, s[16:19], s60 offen sc1 lds
    buffer_load_dwordx4 v4, s[16:19], s60 offen offset:1024 sc1 lds
L67:
    s_add_u32 m0, s63, 32768
    s_add_u32 s60, s65, 8192
    buffer_load_dwordx4 v4, s[16:19], s60 offen sc1 lds
    buffer_load_dwordx4 v4, s[16:19], s60 offen offset:1024 sc1 lds
    s_add_u32 m0, s63, 49152
    s_add_u32 s60, s65, 12288
    buffer_load_dwordx4 v4, s[16:19], s60 offen sc1 lds
    buffer_load_dwordx4 v4, s[16:19], s60 offen offset:1024 sc1 lds
    s_and_b32 s60, s50, 1
    s_lshl_b32 s60, s60, 2
    s_lshr_b32 s61, s50, 1
    s_add_u32 s60, s60, s61
    s_lshl_b32 s72, s60, 12
    s_lshr_b32 s60, s50, 2
    s_lshl_b32 s60, s60, 14
    s_and_b32 s61, s50, 3
    s_lshl_b32 s61, s61, 10
    s_add_u32 s60, s60, s61
    s_add_u32 s60, s60, 65552
    v_and_b32 v128, 3, v2
    v_lshlrev_b32 v30, 8, v128
    v_bfe_u32 v128, v2, 2, 1
    v_lshl_add_u32 v30, v128, 7, v30
    v_and_b32 v128, 3, v3
    v_lshl_add_u32 v30, v128, 5, v30
    v_add_u32 v30, s60, v30
    v_lshrrev_b32 v128, 2, v3
    v_mul_i32_i24 v128, -32784, v128
    v_add_u32 v30, v30, v128
    s_waitcnt vmcnt(6) lgkmcnt(0)
    s_barrier
    ds_read_b128 v[80:83], v22 offset:0
    ds_read_b128 v[84:87], v23 offset:0
    ds_read_b128 v[88:91], v22 offset:2048
    v_lshlrev_b32 v136, 16, v8
    v_and_b32 v137, 0xffff0000, v8
    v_lshlrev_b32 v138, 16, v9
    v_and_b32 v139, 0xffff0000, v9
    v_lshlrev_b32 v140, 16, v10
    ds_read_b128 v[92:95], v23 offset:2048
    v_and_b32 v141, 0xffff0000, v10
    v_lshlrev_b32 v142, 16, v11
    v_and_b32 v143, 0xffff0000, v11
    v_lshlrev_b32 v18, 16, v18
    v_add_f32 v136, v136, v18
    v_add_f32 v137, v137, v18
    v_add_f32 v138, v138, v18
    v_add_f32 v139, v139, v18
    v_add_f32 v140, v140, v18
    v_add_f32 v141, v141, v18
    v_add_f32 v142, v142, v18
    v_add_f32 v143, v143, v18
    s_add_u32 m0, s55, 32768
    s_add_u32 s60, s54, 1310720
    buffer_load_dwordx4 v12, s[28:31], s60 offen lds
    s_add_u32 m0, s55, 40960
    s_add_u32 s60, s54, 1376256
    buffer_load_dwordx4 v12, s[28:31], s60 offen lds
    s_waitcnt vmcnt(6) lgkmcnt(0)
    s_barrier
    v_mfma_f32_32x32x16_bf16 v[48:63], v[32:35], v[80:83], 0
    ds_read_b128 v[96:99], v22 offset:16384
    ds_read_b128 v[100:103], v23 offset:16384
    ds_read_b128 v[104:107], v22 offset:18432
    v_mfma_f32_32x32x16_bf16 v[48:63], v[36:39], v[84:87], v[48:63]
    ds_read_b128 v[108:111], v23 offset:18432
    v_mfma_f32_32x32x16_bf16 v[48:63], v[40:43], v[88:91], v[48:63]
    v_mfma_f32_32x32x16_bf16 v[48:63], v[44:47], v[92:95], v[48:63]
    s_add_u32 m0, s63, 0
    s_add_u32 s60, s65, 16384
    buffer_load_dwordx4 v4, s[16:19], s60 offen sc1 lds
    buffer_load_dwordx4 v4, s[16:19], s60 offen offset:1024 sc1 lds
    s_add_u32 m0, s55, 49152
    s_add_u32 s60, s54, 1441792
    buffer_load_dwordx4 v12, s[28:31], s60 offen lds
    s_add_u32 m0, s55, 57344
    s_add_u32 s60, s54, 1507328
    buffer_load_dwordx4 v12, s[28:31], s60 offen lds
    s_waitcnt vmcnt(8) lgkmcnt(0)
    s_barrier
    v_mfma_f32_32x32x16_bf16 v[48:63], a[0:3], v[96:99], v[48:63]
    ds_read_b128 v[80:83], v22 offset:32768
    ds_read_b128 v[84:87], v23 offset:32768
    ds_read_b128 v[88:91], v22 offset:34816
    v_mfma_f32_32x32x16_bf16 v[48:63], a[4:7], v[100:103], v[48:63]
    ds_read_b128 v[92:95], v23 offset:34816
    v_mfma_f32_32x32x16_bf16 v[48:63], a[8:11], v[104:107], v[48:63]
    v_mfma_f32_32x32x16_bf16 v[48:63], a[12:15], v[108:111], v[48:63]
    s_mov_b64 exec, 1
    buffer_load_dword v19, v4, s[16:19], s69 offen sc1
    s_mov_b64 exec, -1
    s_add_u32 m0, s63, 16384
    s_add_u32 s60, s65, 20480
    buffer_load_dwordx4 v4, s[16:19], s60 offen sc1 lds
    buffer_load_dwordx4 v4, s[16:19], s60 offen offset:1024 sc1 lds
    s_waitcnt vmcnt(9) lgkmcnt(0)
    s_barrier
    v_mfma_f32_32x32x16_bf16 v[48:63], a[16:19], v[80:83], v[48:63]
    ds_read_b128 v[96:99], v22 offset:49152
    ds_read_b128 v[100:103], v23 offset:49152
    ds_read_b128 v[104:107], v22 offset:51200
    v_mfma_f32_32x32x16_bf16 v[48:63], a[20:23], v[84:87], v[48:63]
    ds_read_b128 v[108:111], v23 offset:51200
    v_mfma_f32_32x32x16_bf16 v[48:63], a[24:27], v[88:91], v[48:63]
    v_mfma_f32_32x32x16_bf16 v[48:63], a[28:31], v[92:95], v[48:63]
    s_add_u32 m0, s63, 32768
    s_add_u32 s60, s65, 24576
    buffer_load_dwordx4 v4, s[16:19], s60 offen sc1 lds
    buffer_load_dwordx4 v4, s[16:19], s60 offen offset:1024 sc1 lds
    s_waitcnt vmcnt(4) lgkmcnt(0)
    s_barrier
    v_mfma_f32_32x32x16_bf16 v[48:63], a[32:35], v[96:99], v[48:63]
    ds_read_b128 v[80:83], v22 offset:0
    ds_read_b128 v[84:87], v23 offset:0
    ds_read_b128 v[88:91], v22 offset:2048
    v_mfma_f32_32x32x16_bf16 v[48:63], a[36:39], v[100:103], v[48:63]
    ds_read_b128 v[92:95], v23 offset:2048
    v_mfma_f32_32x32x16_bf16 v[48:63], a[40:43], v[104:107], v[48:63]
    v_mfma_f32_32x32x16_bf16 v[48:63], a[44:47], v[108:111], v[48:63]
    s_mov_b64 exec, 1
    s_mov_b32 s61, 200000
L78:
    v_cmp_ne_u32 vcc, 28, v19
    s_cbranch_vccz L79
    buffer_load_dword v19, v4, s[16:19], s69 offen sc1
    s_waitcnt vmcnt(0)
    s_sub_u32 s61, s61, 1
    s_cmp_lg_u32 s61, 0
    s_cbranch_scc1 L78
L79:
    s_mov_b64 exec, -1
    s_add_u32 m0, s63, 49152
    s_add_u32 s60, s65, 114688
    buffer_load_dwordx4 v4, s[16:19], s60 offen sc1 lds
    buffer_load_dwordx4 v4, s[16:19], s60 offen offset:1024 sc1 lds
    s_waitcnt vmcnt(4) lgkmcnt(0)
    s_barrier
    v_mfma_f32_32x32x16_bf16 v[48:63], a[48:51], v[80:83], v[48:63]
    ds_read_b128 v[96:99], v22 offset:16384
    ds_read_b128 v[100:103], v23 offset:16384
    ds_read_b128 v[104:107], v22 offset:18432
    v_mfma_f32_32x32x16_bf16 v[48:63], a[52:55], v[84:87], v[48:63]
    ds_read_b128 v[108:111], v23 offset:18432
    ds_read_b64_tr_b16 a[64:65], v13 offset:0
    ds_read_b64_tr_b16 a[66:67], v13 offset:256
    v_mfma_f32_32x32x16_bf16 v[48:63], a[56:59], v[88:91], v[48:63]
    ds_read_b64_tr_b16 a[68:69], v13 offset:8192
    ds_read_b64_tr_b16 a[70:71], v13 offset:8448
    ds_read_b64_tr_b16 a[72:73], v13 offset:16384
    v_mfma_f32_32x32x16_bf16 v[48:63], a[60:63], v[92:95], v[48:63]
    ds_read_b64_tr_b16 a[74:75], v13 offset:16640
    ds_read_b64_tr_b16 a[76:77], v13 offset:24576
    ds_read_b64_tr_b16 a[78:79], v13 offset:24832
    s_add_u32 m0, s63, 0
    s_add_u32 s60, s65, 118784
    buffer_load_dwordx4 v4, s[16:19], s60 offen sc1 lds
    buffer_load_dwordx4 v4, s[16:19], s60 offen offset:1024 sc1 lds
    s_waitcnt vmcnt(4) lgkmcnt(0)
    s_barrier
    v_mfma_f32_32x32x16_bf16 v[48:63], a[64:67], v[96:99], v[48:63]
    ds_read_b128 v[80:83], v22 offset:32768
    ds_read_b128 v[84:87], v23 offset:32768
    ds_read_b128 v[88:91], v22 offset:34816
    v_mfma_f32_32x32x16_bf16 v[48:63], a[68:71], v[100:103], v[48:63]
    ds_read_b128 v[92:95], v23 offset:34816
    v_mfma_f32_32x32x16_bf16 v[48:63], a[72:75], v[104:107], v[48:63]
    v_mfma_f32_32x32x16_bf16 v[48:63], a[76:79], v[108:111], v[48:63]
    s_add_u32 m0, s63, 16384
    s_add_u32 s60, s65, 122880
    buffer_load_dwordx4 v4, s[16:19], s60 offen sc1 lds
    buffer_load_dwordx4 v4, s[16:19], s60 offen offset:1024 sc1 lds
    s_waitcnt vmcnt(4) lgkmcnt(0)
    s_barrier
    v_mfma_f32_32x32x16_bf16 v[48:63], v[112:115], v[80:83], v[48:63]
    ds_read_b128 v[96:99], v22 offset:49152
    ds_read_b128 v[100:103], v23 offset:49152
    ds_read_b128 v[104:107], v22 offset:51200
    v_mfma_f32_32x32x16_bf16 v[48:63], v[116:119], v[84:87], v[48:63]
    ds_read_b128 v[108:111], v23 offset:51200
    v_mfma_f32_32x32x16_bf16 v[48:63], v[120:123], v[88:91], v[48:63]
    v_mfma_f32_32x32x16_bf16 v[48:63], v[124:127], v[92:95], v[48:63]
    s_add_u32 m0, s63, 32768
    s_add_u32 s60, s65, 126976
    buffer_load_dwordx4 v4, s[16:19], s60 offen sc1 lds
    buffer_load_dwordx4 v4, s[16:19], s60 offen offset:1024 sc1 lds
    s_waitcnt vmcnt(4) lgkmcnt(0)
    s_barrier
    v_mfma_f32_32x32x16_bf16 v[64:79], v[32:35], v[96:99], 0
    ds_read_b128 v[80:83], v22 offset:0
    ds_read_b128 v[84:87], v23 offset:0
    ds_read_b128 v[88:91], v22 offset:2048
    v_mfma_f32_32x32x16_bf16 v[64:79], v[36:39], v[100:103], v[64:79]
    ds_read_b128 v[92:95], v23 offset:2048
    v_mfma_f32_32x32x16_bf16 v[64:79], v[40:43], v[104:107], v[64:79]
    v_mfma_f32_32x32x16_bf16 v[64:79], v[44:47], v[108:111], v[64:79]
    s_add_u32 m0, s63, 49152
    s_add_u32 s60, s65, 131072
    buffer_load_dwordx4 v4, s[16:19], s60 offen sc1 lds
    buffer_load_dwordx4 v4, s[16:19], s60 offen offset:1024 sc1 lds
    s_waitcnt vmcnt(4) lgkmcnt(0)
    s_barrier
    v_mfma_f32_32x32x16_bf16 v[64:79], a[0:3], v[80:83], v[64:79]
    ds_read_b128 v[96:99], v22 offset:16384
    ds_read_b128 v[100:103], v23 offset:16384
    ds_read_b128 v[104:107], v22 offset:18432
    v_mfma_f32_32x32x16_bf16 v[64:79], a[4:7], v[84:87], v[64:79]
    ds_read_b128 v[108:111], v23 offset:18432
    v_mfma_f32_32x32x16_bf16 v[64:79], a[8:11], v[88:91], v[64:79]
    v_mfma_f32_32x32x16_bf16 v[64:79], a[12:15], v[92:95], v[64:79]
    s_add_u32 m0, s63, 0
    s_add_u32 s60, s65, 135168
    buffer_load_dwordx4 v4, s[16:19], s60 offen sc1 lds
    buffer_load_dwordx4 v4, s[16:19], s60 offen offset:1024 sc1 lds
    s_waitcnt vmcnt(4) lgkmcnt(0)
    s_barrier
    v_mfma_f32_32x32x16_bf16 v[64:79], a[16:19], v[96:99], v[64:79]
    ds_read_b128 v[80:83], v22 offset:32768
    ds_read_b128 v[84:87], v23 offset:32768
    ds_read_b128 v[88:91], v22 offset:34816
    v_mfma_f32_32x32x16_bf16 v[64:79], a[20:23], v[100:103], v[64:79]
    ds_read_b128 v[92:95], v23 offset:34816
    v_mfma_f32_32x32x16_bf16 v[64:79], a[24:27], v[104:107], v[64:79]
    v_mfma_f32_32x32x16_bf16 v[64:79], a[28:31], v[108:111], v[64:79]
    s_add_u32 m0, s63, 16384
    s_add_u32 s60, s65, 139264
    buffer_load_dwordx4 v4, s[16:19], s60 offen sc1 lds
    buffer_load_dwordx4 v4, s[16:19], s60 offen offset:1024 sc1 lds
    s_lshl_b32 s60, s51, 30
    s_add_u32 s60, s60, s57
    buffer_load_dword v129, v5, s[40:43], s60 offen sc1
    s_lshl_b32 s60, s48, 3
    s_add_u32 s60, s60, s49
    s_lshl_b32 s60, s60, 10
    s_add_u32 s60, s60, 12845056
    v_lshlrev_b32 v130, 3, v1
    buffer_load_dword v130, v130, s[16:19], s60 offen sc1
    s_lshr_b32 s60, s2, 3
    s_lshl_b32 s60, s60, 3
    s_add_u32 s60, s60, s50
    s_mul_i32 s60, s60, 6144
    s_add_u32 s60, s60, 384
    v_min_u32 v128, 5, v1
    v_lshlrev_b32 v128, 10, v128
    buffer_load_dword v128, v128, s[12:15], s60 offen
    s_waitcnt vmcnt(7) lgkmcnt(0)
    s_barrier
    v_mfma_f32_32x32x16_bf16 v[64:79], a[32:35], v[80:83], v[64:79]
    ds_read_b128 v[96:99], v22 offset:49152
    ds_read_b128 v[100:103], v23 offset:49152
    ds_read_b128 v[104:107], v22 offset:51200
    v_mfma_f32_32x32x16_bf16 v[64:79], a[36:39], v[84:87], v[64:79]
    ds_read_b128 v[108:111], v23 offset:51200
    v_mfma_f32_32x32x16_bf16 v[64:79], a[40:43], v[88:91], v[64:79]
    v_mfma_f32_32x32x16_bf16 v[64:79], a[44:47], v[92:95], v[64:79]
    s_waitcnt vmcnt(5) lgkmcnt(0)
    s_barrier
    v_mfma_f32_32x32x16_bf16 v[64:79], a[48:51], v[96:99], v[64:79]
    ds_read_b128 v[80:83], v22 offset:0
    ds_read_b128 v[84:87], v23 offset:0
    ds_read_b128 v[88:91], v22 offset:2048
    v_mfma_f32_32x32x16_bf16 v[64:79], a[52:55], v[100:103], v[64:79]
    ds_read_b128 v[92:95], v23 offset:2048
    v_mfma_f32_32x32x16_bf16 v[64:79], a[56:59], v[104:107], v[64:79]
    v_mfma_f32_32x32x16_bf16 v[64:79], a[60:63], v[108:111], v[64:79]
    s_waitcnt vmcnt(3) lgkmcnt(0)
    s_barrier
    v_mfma_f32_32x32x16_bf16 v[64:79], a[64:67], v[80:83], v[64:79]
    ds_read_b128 v[96:99], v22 offset:16384
    ds_read_b128 v[100:103], v23 offset:16384
    ds_read_b128 v[104:107], v22 offset:18432
    ds_read_b128 v[108:111], v23 offset:18432
    s_add_u32 m0, s72, 3860
    s_nop 0
    ds_write_addtid_b32 v48 offset:61692
    v_mfma_f32_32x32x16_bf16 v[64:79], a[68:71], v[84:87], v[64:79]
    ds_write_addtid_b32 v49 offset:61948
    ds_write_addtid_b32 v50 offset:62204
    ds_write_addtid_b32 v51 offset:62460
    ds_write_addtid_b32 v52 offset:62716
    ds_write_addtid_b32 v53 offset:62972
    v_mfma_f32_32x32x16_bf16 v[64:79], a[72:75], v[88:91], v[64:79]
    ds_write_addtid_b32 v54 offset:63228
    ds_write_addtid_b32 v55 offset:63484
    ds_write_addtid_b32 v56 offset:63740
    ds_write_addtid_b32 v57 offset:63996
    ds_write_addtid_b32 v58 offset:64252
    v_mfma_f32_32x32x16_bf16 v[64:79], a[76:79], v[92:95], v[64:79]
    ds_write_addtid_b32 v59 offset:64508
    ds_write_addtid_b32 v60 offset:64764
    ds_write_addtid_b32 v61 offset:65020
    ds_write_addtid_b32 v62 offset:65276
    ds_write_addtid_b32 v63 offset:65532
    s_waitcnt lgkmcnt(15)
    v_mfma_f32_32x32x16_bf16 v[64:79], v[112:115], v[96:99], v[64:79]
    v_mfma_f32_32x32x16_bf16 v[64:79], v[116:119], v[100:103], v[64:79]
    v_mfma_f32_32x32x16_bf16 v[64:79], v[120:123], v[104:107], v[64:79]
    v_mfma_f32_32x32x16_bf16 v[64:79], v[124:127], v[108:111], v[64:79]
    s_nop 9
    s_add_u32 m0, s72, 32768
    s_nop 0
    ds_write_addtid_b32 v64 offset:0
    ds_write_addtid_b32 v65 offset:256
    ds_write_addtid_b32 v66 offset:512
    ds_write_addtid_b32 v67 offset:768
    ds_write_addtid_b32 v68 offset:1024
    ds_write_addtid_b32 v69 offset:1280
    ds_write_addtid_b32 v70 offset:1536
    ds_write_addtid_b32 v71 offset:1792
    ds_write_addtid_b32 v72 offset:2048
    ds_write_addtid_b32 v73 offset:2304
    ds_write_addtid_b32 v74 offset:2560
    ds_write_addtid_b32 v75 offset:2816
    ds_write_addtid_b32 v76 offset:3072
    ds_write_addtid_b32 v77 offset:3328
    ds_write_addtid_b32 v78 offset:3584
    ds_write_addtid_b32 v79 offset:3840
    s_cmp_lg_u32 s51, 0
    s_cbranch_scc1 L80
    s_mov_b32 s60, s64
    s_add_u32 m0, s55, 40960
    s_add_u32 s60, s60, 1024
    buffer_load_dwordx4 v14, s[12:15], s60 offen lds
    s_mov_b32 s60, s64
    s_add_u32 m0, s55, 49152
    s_add_u32 s60, s60, 2048
    buffer_load_dwordx4 v14, s[12:15], s60 offen lds
    s_mov_b32 s60, s64
    s_add_u32 m0, s55, 57344
    s_add_u32 s60, s60, 197632
    buffer_load_dwordx4 v14, s[12:15], s60 offen lds
    v_mov_b32 v20, 0
    v_mov_b32 v21, 0
    v_mov_b32 v22, 0x3f803f80
    v_lshlrev_b32 v23, 3, v2
    s_mov_b32 s70, 0x01010101
    s_mov_b32 s71, 0x01010101
    s_lshl_b32 s69, s48, 3
    s_add_u32 s69, s69, s49
    s_lshl_b32 s69, s69, 10
    s_add_u32 s69, s69, 12845056
L80:
    s_waitcnt lgkmcnt(0)
    s_barrier
    ds_read_b128 v[80:83], v30 offset:0
    ds_read_b128 v[84:87], v30 offset:16
    ds_read_b128 v[88:91], v30 offset:4096
    ds_read_b128 v[92:95], v30 offset:4112
    ds_read_b128 v[96:99], v30 offset:8192
    ds_read_b128 v[100:103], v30 offset:8208
    ds_read_b128 v[104:107], v30 offset:12288
    ds_read_b128 v[108:111], v30 offset:12304
    s_waitcnt lgkmcnt(6)
    v_pk_add_f32 v[80:81], v[80:81], v[136:137]
    v_pk_add_f32 v[82:83], v[82:83], v[138:139]
    v_pk_add_f32 v[84:85], v[84:85], v[140:141]
    v_pk_add_f32 v[86:87], v[86:87], v[142:143]
    s_waitcnt lgkmcnt(4)
    v_pk_add_f32 v[80:81], v[80:81], v[88:89]
    v_pk_add_f32 v[82:83], v[82:83], v[90:91]
    v_pk_add_f32 v[84:85], v[84:85], v[92:93]
    v_pk_add_f32 v[86:87], v[86:87], v[94:95]
    s_waitcnt lgkmcnt(2)
    v_pk_add_f32 v[80:81], v[80:81], v[96:97]
    v_pk_add_f32 v[82:83], v[82:83], v[98:99]
    v_pk_add_f32 v[84:85], v[84:85], v[100:101]
    v_pk_add_f32 v[86:87], v[86:87], v[102:103]
    s_waitcnt lgkmcnt(0)
    v_pk_add_f32 v[80:81], v[80:81], v[104:105]
    v_pk_add_f32 v[82:83], v[82:83], v[106:107]
    v_pk_add_f32 v[84:85], v[84:85], v[108:109]
    v_pk_add_f32 v[86:87], v[86:87], v[110:111]
    v_cvt_pk_bf16_f32 v8, v80, v81
    v_cvt_pk_bf16_f32 v9, v82, v83
    v_cvt_pk_bf16_f32 v10, v84, v85
    v_cvt_pk_bf16_f32 v11, v86, v87
    s_cmp_eq_u32 s51, 0
    s_cbranch_scc1 L81
    buffer_store_dwordx4 v[8:11], v5, s[40:43], s57 offen sc1
    s_branch L_fin
L81:
    s_cmp_eq_u32 s56, 1
    s_cbranch_scc1 L82
    buffer_store_dwordx4 v[8:11], v5, s[40:43], s57 offen sc1
    s_branch L83
L82:
    buffer_store_dwordx4 v[8:11], v5, s[40:43], s57 offen
L83:
    s_cmp_lg_u32 s51, 0
    s_cbranch_scc1 L_fin
    v_dot2c_f32_bf16 v20, v8, v22
    v_dot2c_f32_bf16 v21, v8, v8
    v_dot2c_f32_bf16 v20, v9, v22
    v_dot2c_f32_bf16 v21, v9, v9
    v_dot2c_f32_bf16 v20, v10, v22
    v_dot2c_f32_bf16 v21, v10, v10
    v_dot2c_f32_bf16 v20, v11, v22
    v_dot2c_f32_bf16 v21, v11, v11
    s_nop 0
    s_nop 1
    v_add_f32_dpp v20, v20, v20 quad_perm:[1,0,3,2] row_mask:0xf bank_mask:0xf
    v_add_f32_dpp v21, v21, v21 quad_perm:[1,0,3,2] row_mask:0xf bank_mask:0xf
    s_nop 1
    v_add_f32_dpp v20, v20, v20 quad_perm:[2,3,0,1] row_mask:0xf bank_mask:0xf
    v_add_f32_dpp v21, v21, v21 quad_perm:[2,3,0,1] row_mask:0xf bank_mask:0xf
    s_nop 1
    v_add_f32_dpp v20, v20, v20 row_half_mirror row_mask:0xf bank_mask:0xf
    v_add_f32_dpp v21, v21, v21 row_half_mirror row_mask:0xf bank_mask:0xf
    s_mov_b64 exec, s[70:71]
    s_cmp_eq_u32 s56, 1
    s_cbranch_scc1 L84
    buffer_store_dwordx2 v[20:21], v23, s[16:19], s69 offen sc1
    s_branch L85
L84:
    buffer_store_dwordx2 v[20:21], v23, s[16:19], s69 offen
L85:
    s_mov_b64 exec, -1
    s_mov_b32 s60, s64
    s_add_u32 m0, s55, 65536
    s_add_u32 s60, s60, 198656
    buffer_load_dwordx4 v14, s[12:15], s60 offen lds
    s_mov_b32 s60, s64
    s_add_u32 m0, s55, 73728
    s_add_u32 s60, s60, 394240
    buffer_load_dwordx4 v14, s[12:15], s60 offen lds
    s_mov_b32 s60, s64
    s_add_u32 m0, s55, 81920
    s_add_u32 s60, s60, 395264
    buffer_load_dwordx4 v14, s[12:15], s60 offen lds
    s_mov_b32 s60, s64
    s_add_u32 m0, s55, 90112
    s_add_u32 s60, s60, 590848
    buffer_load_dwordx4 v14, s[12:15], s60 offen lds
    s_waitcnt vmcnt(4)
    s_barrier
    s_cmp_lg_u32 s50, 4
    s_cbranch_scc1 L86
    s_lshl_b32 s60, s48, 7
    s_add_u32 s60, s60, 28672
    s_add_u32 s60, s60, s53
    s_lshl_b32 s61, s49, 4
    s_add_u32 s60, s60, s61
    v_mov_b32 v16, 1
    s_mov_b64 exec, 1
    s_cmp_eq_u32 s56, 1
    s_cbranch_scc1 L87
    buffer_store_dword v16, v4, s[16:19], s60 offen sc1
    s_branch L88
L87:
    buffer_store_dword v16, v4, s[16:19], s60 offen
L88:
    s_mov_b64 exec, -1
L86:
    s_mov_b32 s8, s40
    s_mov_b32 s9, s41
    s_mov_b32 s40, s58
    s_mov_b32 s41, s59
    s_mov_b32 s51, 1
    s_mov_b32 s52, 16777216
    s_branch L_layer
L_fin:
L_end:
    s_endpgm
L_softmax_safe:
    s_waitcnt lgkmcnt(0)
    s_lshl_b32 s72, s64, 17
    s_add_u32 s72, s72, s52
    v_mov_b32 v116, 0xff800000
    s_mov_b32 s73, s72
    s_mov_b32 s74, 64
L89:
    buffer_load_dwordx4 v[104:107], v4, s[16:19], s73 offen sc1
    s_waitcnt vmcnt(0)
    v_mfma_f32_32x32x16_bf16 v[48:63], v[104:107], v[28:31], 0
    s_nop 15
    v_max3_f32 v116, v116, v48, v49
    v_max3_f32 v116, v116, v50, v51
    v_max3_f32 v116, v116, v52, v53
    v_max3_f32 v116, v116, v54, v55
    v_max3_f32 v116, v116, v56, v57
    v_max3_f32 v116, v116, v58, v59
    v_max3_f32 v116, v116, v60, v61
    v_max3_f32 v116, v116, v62, v63
    s_add_u32 s73, s73, 2048
    s_sub_u32 s74, s74, 1
    s_cmp_lg_u32 s74, 0
    s_cbranch_scc1 L89
    v_mov_b32 v117, v116
    s_nop 1
    v_permlane32_swap_b32 v116, v117
    s_nop 1
    v_max_f32 v116, v116, v117
    v_sub_f32 v80, 0, v116
    v_mov_b32 v120, 0
    v_sub_f32 v81, 0, v116
    v_mov_b32 v121, 0
    v_sub_f32 v82, 0, v116
    v_mov_b32 v122, 0
    v_sub_f32 v83, 0, v116
    v_mov_b32 v123, 0
    v_sub_f32 v84, 0, v116
    v_mov_b32 v124, 0
    v_sub_f32 v85, 0, v116
    v_mov_b32 v125, 0
    v_sub_f32 v86, 0, v116
    v_mov_b32 v126, 0
    v_sub_f32 v87, 0, v116
    v_mov_b32 v127, 0
    v_sub_f32 v88, 0, v116
    v_mov_b32 v128, 0
    v_sub_f32 v89, 0, v116
    v_mov_b32 v129, 0
    v_sub_f32 v90, 0, v116
    v_mov_b32 v130, 0
    v_sub_f32 v91, 0, v116
    v_mov_b32 v131, 0
    v_sub_f32 v92, 0, v116
    v_mov_b32 v132, 0
    v_sub_f32 v93, 0, v116
    v_mov_b32 v133, 0
    v_sub_f32 v94, 0, v116
    v_mov_b32 v134, 0
    v_sub_f32 v95, 0, v116
    v_mov_b32 v135, 0
    v_mov_b32 v108, 0x3f803f80
    v_mov_b32 v109, 0x3f803f80
    v_mov_b32 v110, 0x3f803f80
    v_mov_b32 v111, 0x3f803f80
    v_mov_b32 v112, 0x3f803f80
    v_mov_b32 v113, 0x3f803f80
    v_mov_b32 v114, 0x3f803f80
    v_mov_b32 v115, 0x3f803f80
    v_lshrrev_b32 v116, 5, v1
    v_lshlrev_b32 v117, 8, v116
    v_and_b32 v116, 15, v1
    v_lshl_add_u32 v117, v116, 4, v117
    s_mov_b32 s73, s72
    s_mov_b32 s74, 64
L90:
    buffer_load_dwordx4 v[104:107], v4, s[16:19], s73 offen sc1
    s_mov_b32 exec_lo, 0xffff
    s_mov_b32 exec_hi, 0xffff
    buffer_load_dwordx4 v[108:111], v117, s[16:19], s73 offen offset:1024 sc1
    buffer_load_dwordx4 v[112:115], v117, s[16:19], s73 offen offset:1536 sc1
    s_mov_b64 exec, -1
    s_waitcnt vmcnt(0)
    v_mfma_f32_32x32x16_bf16 v[48:63], v[104:107], v[28:31], v[80:95]
    s_nop 15
    v_exp_f32 v48, v48
    v_exp_f32 v49, v49
    v_exp_f32 v50, v50
    v_exp_f32 v51, v51
    v_exp_f32 v52, v52
    v_exp_f32 v53, v53
    v_exp_f32 v54, v54
    v_exp_f32 v55, v55
    v_exp_f32 v56, v56
    v_exp_f32 v57, v57
    v_exp_f32 v58, v58
    v_exp_f32 v59, v59
    v_exp_f32 v60, v60
    v_exp_f32 v61, v61
    v_exp_f32 v62, v62
    v_exp_f32 v63, v63
    s_nop 1
    v_smfmac_f32_32x32x32_bf16 v[120:135], v[108:111], v[48:55], v19
    v_smfmac_f32_32x32x32_bf16 v[120:135], v[112:115], v[56:63], v19
    s_nop 15
    s_add_u32 s73, s73, 2048
    s_sub_u32 s74, s74, 1
    s_cmp_lg_u32 s74, 0
    s_cbranch_scc1 L90
    v_mov_b32 v64, v120
    v_mov_b32 v65, v121
    v_mov_b32 v66, v122
    v_mov_b32 v67, v123
    v_mov_b32 v68, v124
    v_mov_b32 v69, v125
    v_mov_b32 v70, v126
    v_mov_b32 v71, v127
    v_mov_b32 v72, v128
    ds_read_b64_tr_b16 v[80:81], v20 offset:0
    ds_read_b64_tr_b16 v[82:83], v20 offset:1024
    ds_read_b64_tr_b16 v[84:85], v22 offset:0
    ds_read_b64_tr_b16 v[86:87], v22 offset:1024
    ds_read_b64_tr_b16 v[88:89], v20 offset:2048
    ds_read_b64_tr_b16 v[90:91], v20 offset:3072
    ds_read_b64_tr_b16 v[92:93], v22 offset:2048
    ds_read_b64_tr_b16 v[94:95], v22 offset:3072
    s_branch L_softmax_done
.section .rodata,"a"
.p2align 6
.amdhsa_kernel interleave_layers__softmax_full_mha__mixer_token_mlp__prompt_kernel
  .amdhsa_next_free_vgpr 256
  .amdhsa_next_free_sgpr 102
  .amdhsa_accum_offset 144
  .amdhsa_group_segment_fixed_size 0
  .amdhsa_kernarg_size 88
  .amdhsa_user_sgpr_count 2
  .amdhsa_user_sgpr_kernarg_segment_ptr 1
  .amdhsa_system_sgpr_workgroup_id_x 1
.end_amdhsa_kernel
```
